```python
import torch

def _softmax(x, axis=-1):
    return torch.softmax(x, dim=axis)
def _gelu(x):
    return torch.nn.functional.gelu(x, approximate="tanh")
def _silu(x):
    return torch.nn.functional.silu(x)
def _sigmoid(x):
    return torch.sigmoid(x)
def _layernorm(x, axis=-1, eps=1e-5):
    m = x.mean(dim=axis, keepdim=True)
    v = x.var(dim=axis, keepdim=True, unbiased=False)
    return (x - m) / torch.sqrt(v + eps)
def _scatter_add(tgt, idx, src, axis=0):
    return tgt.clone().index_add_(axis, idx, src)
def _segment_sum(src, seg, n):
    out = torch.zeros((n,) + src.shape[1:], dtype=src.dtype)
    return out.index_add_(0, seg, src)
def _pad(x, pw):
    flat = tuple(v for pair in reversed(pw) for v in pair)
    return torch.nn.functional.pad(x, flat)

kernel_name = 'concat_heads__gqa_block_cached__compressed_kv_cla__decode'

def setup_inputs():

    _w = (lambda a: (lambda t: t.to(torch.bfloat16) if t.is_floating_point() else t)(torch.as_tensor(a)))
    def _A_setup():
        B, Sq, D = 2, 1, 576
        Hq, Hkv, Sk, Dh = 32, 16, 4096, 128
        assert Hq % Hkv == 0, (Hq, Hkv)
        return {
            "x": _w((lambda *s: torch.randn(*s, dtype=torch.bfloat16) * 1.6)(B, Sq, D)),
            "k_cache": _w((lambda *s: torch.randn(*s, dtype=torch.bfloat16) * 1.6)(B, Hkv, Sk, Dh)),
            "v_cache": _w((lambda *s: torch.randn(*s, dtype=torch.bfloat16) * 0.05)(B, Hkv, Sk, Dh)),
            "wq": _w((lambda *s: torch.randn(*s, dtype=torch.bfloat16) * 1.6)(D, Hq * Dh) * (D ** -0.5)),
            "wo": _w((lambda *s: torch.randn(*s, dtype=torch.bfloat16) * 0.05)(Hq * Dh, D) * ((Hq * Dh) ** -0.5)),
        }
    _A_in = _A_setup()

    def _B_setup():
        B, H, Sq, Sk, D, M = 2, 32, 1, 4096, 128, 576
        Dc = 4 * D
        return {
            "x": _w((lambda *s: torch.randn(*s, dtype=torch.bfloat16) * 3.2)(B, Sq, M)),
            "c_kv": _w((lambda *s: torch.randn(*s, dtype=torch.bfloat16) * 0.1)(B, Sk, Dc)),
            "w_q": _w((lambda *s: torch.randn(*s, dtype=torch.bfloat16) * 6.4)(M, H, D) * (M ** -0.5)),
            "w_uk": _w((lambda *s: torch.randn(*s, dtype=torch.bfloat16) * 6.4)(Dc, H, D) * (Dc ** -0.5)),
            "w_uv": _w((lambda *s: torch.randn(*s, dtype=torch.bfloat16) * 0.1)(Dc, H, D) * (Dc ** -0.5)),
            "w_o": _w((lambda *s: torch.randn(*s, dtype=torch.bfloat16) * 0.1)(H, D, M) * ((H * D) ** -0.5)),
        }
    _B_in = _B_setup()

    return {
        "A_x": _A_in["x"],
        "A_k_cache": _A_in["k_cache"],
        "A_v_cache": _A_in["v_cache"],
        "A_wq": _A_in["wq"],
        "A_wo": _A_in["wo"],
        "B_x": _B_in["x"],
        "B_c_kv": _B_in["c_kv"],
        "B_w_q": _B_in["w_q"],
        "B_w_uk": _B_in["w_uk"],
        "B_w_uv": _B_in["w_uv"],
        "B_w_o": _B_in["w_o"],
    }

def reference(A_x, A_k_cache, A_v_cache, A_wq, A_wo, B_x, B_c_kv, B_w_q, B_w_uk, B_w_uv, B_w_o):
    def _A_ref(x, k_cache, v_cache, wq, wo):
        B, Sq, D = x.shape
        Hq, Dh = 32, 128
        Hkv = k_cache.shape[1]
        rep = Hq // Hkv
        q = (lambda x, *d: x.permute(*d))((x @ wq).reshape(B, Sq, Hq, Dh), 0, 2, 1, 3)
        k = (lambda x, n, axis: torch.repeat_interleave(x, n, dim=axis))(k_cache, rep, axis=1)
        v = (lambda x, n, axis: torch.repeat_interleave(x, n, dim=axis))(v_cache, rep, axis=1)
        scores = torch.einsum("bhqd,bhkd->bhqk", q, k) * (Dh ** -0.5)
        p = _softmax(scores, axis=-1)
        o = torch.einsum("bhqk,bhkd->bhqd", p, v)
        return (lambda x, *d: x.permute(*d))(o, 0, 2, 1, 3).reshape(B, Sq, Hq * Dh) @ wo

    def _B_ref(x, c_kv, w_q, w_uk, w_uv, w_o):
        B, Sq, M = x.shape[0], x.shape[1], x.shape[2]
        Sk = c_kv.shape[1]
        H, D = w_q.shape[1], w_q.shape[2]
        q = torch.einsum("bqm,mhd->bhqd", x, w_q)
        k = torch.einsum("bkc,chd->bhkd", c_kv, w_uk)
        v = torch.einsum("bkc,chd->bhkd", c_kv, w_uv)
        scores = torch.einsum("bhqd,bhkd->bhqk", q, k) * (D ** -0.5)
        off = Sk - Sq
        qi = torch.arange(Sq)[:, None]
        kj = torch.arange(Sk)[None, :]
        cmask = kj <= (qi + off)
        scores = torch.where(cmask[None, None], scores, -1e9)
        p = _softmax(scores, axis=-1)
        ctx = torch.einsum("bhqk,bhkd->bhqd", p, v)
        return torch.einsum("bhqd,hdm->bqm", ctx, w_o)

    a = _A_ref(A_x, A_k_cache, A_v_cache, A_wq, A_wo)
    b = _B_ref(B_x, B_c_kv, B_w_q, B_w_uk, B_w_uv, B_w_o)
    return torch.concatenate([a, b], axis=-1)
```

```asm
; @launch grid=(256,1,1) block=(512,1,1) lds=138240
.amdgcn_target "amdgcn-amd-amdhsa--gfx950"
.text
.globl concat_heads__gqa_block_cached__compressed_kv_cla__decode_kernel
.p2align 8
.type concat_heads__gqa_block_cached__compressed_kv_cla__decode_kernel,@function
concat_heads__gqa_block_cached__compressed_kv_cla__decode_kernel:
    s_cmp_ge_u32 s2, 256
    s_cbranch_scc1 L_end2
    s_load_dwordx16 s[4:19], s[0:1], 0
    s_load_dwordx8 s[20:27], s[0:1], 64
    s_load_dwordx4 s[28:31], s[0:1], 96
    v_and_b32 v56, 63, v0
    v_lshrrev_b32 v59, 6, v0
    v_lshlrev_b32 v60, 2, v56
    v_mov_b32 v61, 0
    v_readfirstlane_b32 s3, v59
    ds_write_b32 v60, v61 offset:0
    s_waitcnt lgkmcnt(0)
    s_mov_b32 s32, s30
    s_mov_b32 s33, s31
    s_mov_b32 s34, 268435456
    s_mov_b32 s35, 0x00020000
    s_mov_b32 s36, s28
    s_mov_b32 s37, s29
    s_mov_b32 s38, 256
    s_mov_b32 s39, 0x00020000
    s_mov_b32 s91, s3
    s_barrier
    s_cmp_ge_u32 s3, 4
    s_cbranch_scc1 L_helper
    s_mov_b32 s70, 0
    v_mov_b32 v62, 0
    s_mov_b32 s40, s6
    s_mov_b32 s41, s7
    s_mov_b32 s42, 33554432
    s_mov_b32 s43, 0x00020000
    s_mov_b32 s44, s8
    s_mov_b32 s45, s9
    s_mov_b32 s46, 33554432
    s_mov_b32 s47, 0x00020000
    s_mov_b32 s48, s16
    s_mov_b32 s49, s17
    s_mov_b32 s50, 8388608
    s_mov_b32 s51, 0x00020000
    s_lshl_b32 s52, s2, 17
    s_lshl_b32 s53, s3, 15
    s_add_u32 s52, s52, s53
    v_and_b32 v59, 15, v56
    v_bfe_u32 v60, v56, 4, 2
    v_lshlrev_b32 v57, 8, v59
    v_lshl_add_u32 v57, v60, 4, v57
    v_lshlrev_b32 v58, 10, v60
    v_lshl_add_u32 v58, v59, 4, v58
    v_lshlrev_b32 v61, 4, v56
    s_cmp_ge_u32 s2, 128
    s_cbranch_scc1 L_st_nockv
    s_lshl_b32 s54, s2, 16
    s_lshl_b32 s53, s3, 14
    s_add_u32 s54, s54, s53
    s_mul_i32 s55, s3, 16640
    s_add_u32 s53, s54, 0
    s_add_u32 m0, s55, 38400
    s_nop 0
    buffer_load_dwordx4 v61, s[48:51], s53 offen lds
    s_add_u32 s53, s54, 1024
    s_add_u32 m0, s55, 39440
    s_nop 0
    buffer_load_dwordx4 v61, s[48:51], s53 offen lds
    s_add_u32 s53, s54, 2048
    s_add_u32 m0, s55, 40480
    s_nop 0
    buffer_load_dwordx4 v61, s[48:51], s53 offen lds
    s_add_u32 s53, s54, 3072
    s_add_u32 m0, s55, 41520
    s_nop 0
    buffer_load_dwordx4 v61, s[48:51], s53 offen lds
    s_add_u32 s53, s54, 4096
    s_add_u32 m0, s55, 42560
    s_nop 0
    buffer_load_dwordx4 v61, s[48:51], s53 offen lds
    s_add_u32 s53, s54, 5120
    s_add_u32 m0, s55, 43600
    s_nop 0
    buffer_load_dwordx4 v61, s[48:51], s53 offen lds
    s_add_u32 s53, s54, 6144
    s_add_u32 m0, s55, 44640
    s_nop 0
    buffer_load_dwordx4 v61, s[48:51], s53 offen lds
    s_add_u32 s53, s54, 7168
    s_add_u32 m0, s55, 45680
    s_nop 0
    buffer_load_dwordx4 v61, s[48:51], s53 offen lds
    s_add_u32 s53, s54, 8192
    s_add_u32 m0, s55, 46720
    s_nop 0
    buffer_load_dwordx4 v61, s[48:51], s53 offen lds
    s_add_u32 s53, s54, 9216
    s_add_u32 m0, s55, 47760
    s_nop 0
    buffer_load_dwordx4 v61, s[48:51], s53 offen lds
    s_add_u32 s53, s54, 10240
    s_add_u32 m0, s55, 48800
    s_nop 0
    buffer_load_dwordx4 v61, s[48:51], s53 offen lds
    s_add_u32 s53, s54, 11264
    s_add_u32 m0, s55, 49840
    s_nop 0
    buffer_load_dwordx4 v61, s[48:51], s53 offen lds
    s_add_u32 s53, s54, 12288
    s_add_u32 m0, s55, 50880
    s_nop 0
    buffer_load_dwordx4 v61, s[48:51], s53 offen lds
    s_add_u32 s53, s54, 13312
    s_add_u32 m0, s55, 51920
    s_nop 0
    buffer_load_dwordx4 v61, s[48:51], s53 offen lds
    s_add_u32 s53, s54, 14336
    s_add_u32 m0, s55, 52960
    s_nop 0
    buffer_load_dwordx4 v61, s[48:51], s53 offen lds
    s_add_u32 s53, s54, 15360
    s_add_u32 m0, s55, 54000
    s_nop 0
    buffer_load_dwordx4 v61, s[48:51], s53 offen lds
L_st_nockv:
    s_cmp_lt_u32 s2, 128
    s_cbranch_scc1 L_st_lo
    v_mov_b32 v62, 0
LW_1:
    ds_read_b32 v63, v62
    s_waitcnt lgkmcnt(0)
    v_readfirstlane_b32 s90, v63
    s_cmp_ge_u32 s90, 1
    s_cbranch_scc1 LW_1d
    s_sleep 1
    s_branch LW_1
LW_1d:
    s_branch L_st_go
L_st_lo:
    v_mov_b32 v62, 28
LW_2:
    ds_read_b32 v63, v62
    s_waitcnt lgkmcnt(0)
    v_readfirstlane_b32 s90, v63
    s_cmp_ge_u32 s90, 1
    s_cbranch_scc1 LW_2d
    s_sleep 1
    s_branch LW_2
LW_2d:
L_st_go:
    s_add_u32 s53, s52, 0
    buffer_load_dwordx4 a[0:3], v57, s[40:43], s53 offen offset:0
    buffer_load_dwordx4 a[4:7], v57, s[40:43], s53 offen offset:64
    buffer_load_dwordx4 a[8:11], v57, s[40:43], s53 offen offset:128
    buffer_load_dwordx4 a[12:15], v57, s[40:43], s53 offen offset:192
    s_add_u32 s53, s52, 4096
    buffer_load_dwordx4 a[16:19], v57, s[40:43], s53 offen offset:0
    buffer_load_dwordx4 a[20:23], v57, s[40:43], s53 offen offset:64
    buffer_load_dwordx4 a[24:27], v57, s[40:43], s53 offen offset:128
    buffer_load_dwordx4 a[28:31], v57, s[40:43], s53 offen offset:192
    s_add_u32 s53, s52, 8192
    buffer_load_dwordx4 a[32:35], v57, s[40:43], s53 offen offset:0
    buffer_load_dwordx4 a[36:39], v57, s[40:43], s53 offen offset:64
    buffer_load_dwordx4 a[40:43], v57, s[40:43], s53 offen offset:128
    buffer_load_dwordx4 a[44:47], v57, s[40:43], s53 offen offset:192
    s_add_u32 s53, s52, 12288
    buffer_load_dwordx4 a[48:51], v57, s[40:43], s53 offen offset:0
    buffer_load_dwordx4 a[52:55], v57, s[40:43], s53 offen offset:64
    buffer_load_dwordx4 a[56:59], v57, s[40:43], s53 offen offset:128
    buffer_load_dwordx4 a[60:63], v57, s[40:43], s53 offen offset:192
    s_add_u32 s53, s52, 16384
    buffer_load_dwordx4 a[64:67], v57, s[40:43], s53 offen offset:0
    buffer_load_dwordx4 a[68:71], v57, s[40:43], s53 offen offset:64
    buffer_load_dwordx4 a[72:75], v57, s[40:43], s53 offen offset:128
    buffer_load_dwordx4 a[76:79], v57, s[40:43], s53 offen offset:192
    s_add_u32 s53, s52, 20480
    buffer_load_dwordx4 a[80:83], v57, s[40:43], s53 offen offset:0
    buffer_load_dwordx4 a[84:87], v57, s[40:43], s53 offen offset:64
    buffer_load_dwordx4 a[88:91], v57, s[40:43], s53 offen offset:128
    buffer_load_dwordx4 a[92:95], v57, s[40:43], s53 offen offset:192
    s_add_u32 s53, s52, 24576
    buffer_load_dwordx4 a[96:99], v57, s[40:43], s53 offen offset:0
    buffer_load_dwordx4 a[100:103], v57, s[40:43], s53 offen offset:64
    buffer_load_dwordx4 a[104:107], v57, s[40:43], s53 offen offset:128
    buffer_load_dwordx4 a[108:111], v57, s[40:43], s53 offen offset:192
    s_add_u32 s53, s52, 28672
    buffer_load_dwordx4 a[112:115], v57, s[40:43], s53 offen offset:0
    buffer_load_dwordx4 a[116:119], v57, s[40:43], s53 offen offset:64
    buffer_load_dwordx4 a[120:123], v57, s[40:43], s53 offen offset:128
    buffer_load_dwordx4 a[124:127], v57, s[40:43], s53 offen offset:192
    s_add_u32 s53, s52, 0
    buffer_load_dwordx4 v[64:67], v58, s[44:47], s53 offen offset:0
    buffer_load_dwordx4 v[68:71], v58, s[44:47], s53 offen offset:256
    buffer_load_dwordx4 v[72:75], v58, s[44:47], s53 offen offset:512
    buffer_load_dwordx4 v[76:79], v58, s[44:47], s53 offen offset:768
    s_add_u32 s53, s52, 4096
    buffer_load_dwordx4 v[80:83], v58, s[44:47], s53 offen offset:0
    buffer_load_dwordx4 v[84:87], v58, s[44:47], s53 offen offset:256
    buffer_load_dwordx4 v[88:91], v58, s[44:47], s53 offen offset:512
    buffer_load_dwordx4 v[92:95], v58, s[44:47], s53 offen offset:768
    s_add_u32 s53, s52, 8192
    buffer_load_dwordx4 v[96:99], v58, s[44:47], s53 offen offset:0
    buffer_load_dwordx4 v[100:103], v58, s[44:47], s53 offen offset:256
    buffer_load_dwordx4 v[104:107], v58, s[44:47], s53 offen offset:512
    buffer_load_dwordx4 v[108:111], v58, s[44:47], s53 offen offset:768
    s_add_u32 s53, s52, 12288
    buffer_load_dwordx4 v[112:115], v58, s[44:47], s53 offen offset:0
    s_waitcnt vmcnt(60)
    buffer_load_dwordx4 v[116:119], v58, s[44:47], s53 offen offset:256
    s_waitcnt vmcnt(60)
    buffer_load_dwordx4 v[120:123], v58, s[44:47], s53 offen offset:512
    s_waitcnt vmcnt(60)
    buffer_load_dwordx4 v[124:127], v58, s[44:47], s53 offen offset:768
    s_waitcnt vmcnt(60)
    s_waitcnt vmcnt(48)
    s_waitcnt lgkmcnt(0)
    v_mov_b32 v62, 4
    v_mov_b32 v63, 1
    s_mov_b64 exec, 1
    ds_add_u32 v62, v63
    s_mov_b64 exec, -1
    v_mov_b32 v62, 0
LW_3:
    ds_read_b32 v63, v62
    s_waitcnt lgkmcnt(0)
    v_readfirstlane_b32 s90, v63
    s_cmp_ge_u32 s90, 1
    s_cbranch_scc1 LW_3d
    s_sleep 1
    s_branch LW_3
LW_3d:
    v_mov_b32 v32, 0
    v_mov_b32 v33, 0
    v_mov_b32 v34, 0
    v_mov_b32 v35, 0
    v_mov_b32 v36, 0
    v_mov_b32 v37, 0
    v_mov_b32 v38, 0
    v_mov_b32 v39, 0
    v_mov_b32 v40, 0
    v_mov_b32 v41, 0
    v_mov_b32 v42, 0
    v_mov_b32 v43, 0
    v_mov_b32 v44, 0
    v_mov_b32 v45, 0
    v_mov_b32 v46, 0
    v_mov_b32 v47, 0
    v_lshlrev_b32 v61, 8, v59
    v_lshl_add_u32 v61, v60, 4, v61
    v_cmp_gt_u32 vcc, 2, v59
    s_and_saveexec_b64 s[56:57], vcc
    ds_read_b128 v[32:35], v61 offset:256
    ds_read_b128 v[36:39], v61 offset:320
    ds_read_b128 v[40:43], v61 offset:384
    ds_read_b128 v[44:47], v61 offset:448
    s_mov_b64 exec, s[56:57]
    s_waitcnt vmcnt(16) lgkmcnt(0)
    v_mfma_f32_16x16x32_bf16 v[0:3], a[0:3], v[32:35], 0
    v_mfma_f32_16x16x32_bf16 v[0:3], a[4:7], v[36:39], v[0:3]
    v_mfma_f32_16x16x32_bf16 v[0:3], a[8:11], v[40:43], v[0:3]
    v_mfma_f32_16x16x32_bf16 v[0:3], a[12:15], v[44:47], v[0:3]
    v_mfma_f32_16x16x32_bf16 v[4:7], a[16:19], v[32:35], 0
    v_mfma_f32_16x16x32_bf16 v[4:7], a[20:23], v[36:39], v[4:7]
    v_mfma_f32_16x16x32_bf16 v[4:7], a[24:27], v[40:43], v[4:7]
    v_mfma_f32_16x16x32_bf16 v[4:7], a[28:31], v[44:47], v[4:7]
    v_mfma_f32_16x16x32_bf16 v[8:11], a[32:35], v[32:35], 0
    v_mfma_f32_16x16x32_bf16 v[8:11], a[36:39], v[36:39], v[8:11]
    v_mfma_f32_16x16x32_bf16 v[8:11], a[40:43], v[40:43], v[8:11]
    v_mfma_f32_16x16x32_bf16 v[8:11], a[44:47], v[44:47], v[8:11]
    v_mfma_f32_16x16x32_bf16 v[12:15], a[48:51], v[32:35], 0
    v_mfma_f32_16x16x32_bf16 v[12:15], a[52:55], v[36:39], v[12:15]
    v_mfma_f32_16x16x32_bf16 v[12:15], a[56:59], v[40:43], v[12:15]
    v_mfma_f32_16x16x32_bf16 v[12:15], a[60:63], v[44:47], v[12:15]
    v_mfma_f32_16x16x32_bf16 v[16:19], a[64:67], v[32:35], 0
    v_mfma_f32_16x16x32_bf16 v[16:19], a[68:71], v[36:39], v[16:19]
    v_mfma_f32_16x16x32_bf16 v[16:19], a[72:75], v[40:43], v[16:19]
    v_mfma_f32_16x16x32_bf16 v[16:19], a[76:79], v[44:47], v[16:19]
    v_mfma_f32_16x16x32_bf16 v[20:23], a[80:83], v[32:35], 0
    v_mfma_f32_16x16x32_bf16 v[20:23], a[84:87], v[36:39], v[20:23]
    v_mfma_f32_16x16x32_bf16 v[20:23], a[88:91], v[40:43], v[20:23]
    v_mfma_f32_16x16x32_bf16 v[20:23], a[92:95], v[44:47], v[20:23]
    v_mfma_f32_16x16x32_bf16 v[24:27], a[96:99], v[32:35], 0
    v_mfma_f32_16x16x32_bf16 v[24:27], a[100:103], v[36:39], v[24:27]
    v_mfma_f32_16x16x32_bf16 v[24:27], a[104:107], v[40:43], v[24:27]
    v_mfma_f32_16x16x32_bf16 v[24:27], a[108:111], v[44:47], v[24:27]
    v_mfma_f32_16x16x32_bf16 v[28:31], a[112:115], v[32:35], 0
    v_mfma_f32_16x16x32_bf16 v[28:31], a[116:119], v[36:39], v[28:31]
    v_mfma_f32_16x16x32_bf16 v[28:31], a[120:123], v[40:43], v[28:31]
    v_mfma_f32_16x16x32_bf16 v[28:31], a[124:127], v[44:47], v[28:31]
    s_nop 7
    s_add_u32 s53, s52, 16384
    buffer_load_dwordx4 a[0:3], v58, s[44:47], s53 offen offset:0
    buffer_load_dwordx4 a[4:7], v58, s[44:47], s53 offen offset:256
    buffer_load_dwordx4 a[8:11], v58, s[44:47], s53 offen offset:512
    buffer_load_dwordx4 a[12:15], v58, s[44:47], s53 offen offset:768
    s_add_u32 s53, s52, 20480
    buffer_load_dwordx4 a[16:19], v58, s[44:47], s53 offen offset:0
    buffer_load_dwordx4 a[20:23], v58, s[44:47], s53 offen offset:256
    buffer_load_dwordx4 a[24:27], v58, s[44:47], s53 offen offset:512
    buffer_load_dwordx4 a[28:31], v58, s[44:47], s53 offen offset:768
    s_add_u32 s53, s52, 24576
    buffer_load_dwordx4 a[32:35], v58, s[44:47], s53 offen offset:0
    buffer_load_dwordx4 a[36:39], v58, s[44:47], s53 offen offset:256
    buffer_load_dwordx4 a[40:43], v58, s[44:47], s53 offen offset:512
    buffer_load_dwordx4 a[44:47], v58, s[44:47], s53 offen offset:768
    s_add_u32 s53, s52, 28672
    buffer_load_dwordx4 a[48:51], v58, s[44:47], s53 offen offset:0
    buffer_load_dwordx4 a[52:55], v58, s[44:47], s53 offen offset:256
    buffer_load_dwordx4 a[56:59], v58, s[44:47], s53 offen offset:512
    buffer_load_dwordx4 a[60:63], v58, s[44:47], s53 offen offset:768
    s_nop 7
    v_max3_f32 v59, v0, v1, v2
    v_max3_f32 v59, v59, v3, v4
    v_max3_f32 v59, v59, v5, v6
    v_max3_f32 v59, v59, v7, v8
    v_max3_f32 v59, v59, v9, v10
    v_max3_f32 v59, v59, v11, v12
    v_max3_f32 v59, v59, v13, v14
    v_max3_f32 v59, v59, v15, v16
    v_max3_f32 v59, v59, v17, v18
    v_max3_f32 v59, v59, v19, v20
    v_max3_f32 v59, v59, v21, v22
    v_max3_f32 v59, v59, v23, v24
    v_max3_f32 v59, v59, v25, v26
    v_max3_f32 v59, v59, v27, v28
    v_max3_f32 v59, v59, v29, v30
    v_max_f32 v59, v59, v31
    v_xor_b32 v60, 16, v56
    v_lshlrev_b32 v60, 2, v60
    v_xor_b32 v61, 32, v56
    v_lshlrev_b32 v61, 2, v61
    ds_bpermute_b32 v62, v60, v59
    s_waitcnt lgkmcnt(0)
    v_max_f32 v59, v59, v62
    ds_bpermute_b32 v62, v61, v59
    s_waitcnt lgkmcnt(0)
    v_max_f32 v59, v59, v62
    s_mov_b32 s58, 0x3e0293ee
    v_mul_f32 v59, s58, v59
    v_mov_b32 v57, v59
    v_fma_f32 v0, v0, s58, -v59
    v_fma_f32 v1, v1, s58, -v59
    v_fma_f32 v2, v2, s58, -v59
    v_fma_f32 v3, v3, s58, -v59
    v_fma_f32 v4, v4, s58, -v59
    v_fma_f32 v5, v5, s58, -v59
    v_fma_f32 v6, v6, s58, -v59
    v_fma_f32 v7, v7, s58, -v59
    v_fma_f32 v8, v8, s58, -v59
    v_fma_f32 v9, v9, s58, -v59
    v_fma_f32 v10, v10, s58, -v59
    v_fma_f32 v11, v11, s58, -v59
    v_fma_f32 v12, v12, s58, -v59
    v_fma_f32 v13, v13, s58, -v59
    v_fma_f32 v14, v14, s58, -v59
    v_fma_f32 v15, v15, s58, -v59
    v_fma_f32 v16, v16, s58, -v59
    v_fma_f32 v17, v17, s58, -v59
    v_fma_f32 v18, v18, s58, -v59
    v_fma_f32 v19, v19, s58, -v59
    v_fma_f32 v20, v20, s58, -v59
    v_fma_f32 v21, v21, s58, -v59
    v_fma_f32 v22, v22, s58, -v59
    v_fma_f32 v23, v23, s58, -v59
    v_fma_f32 v24, v24, s58, -v59
    v_fma_f32 v25, v25, s58, -v59
    v_fma_f32 v26, v26, s58, -v59
    v_fma_f32 v27, v27, s58, -v59
    v_fma_f32 v28, v28, s58, -v59
    v_fma_f32 v29, v29, s58, -v59
    v_fma_f32 v30, v30, s58, -v59
    v_fma_f32 v31, v31, s58, -v59
    v_exp_f32 v0, v0
    v_exp_f32 v1, v1
    v_exp_f32 v2, v2
    v_exp_f32 v3, v3
    v_exp_f32 v4, v4
    v_exp_f32 v5, v5
    v_exp_f32 v6, v6
    v_exp_f32 v7, v7
    v_exp_f32 v8, v8
    v_exp_f32 v9, v9
    v_exp_f32 v10, v10
    v_exp_f32 v11, v11
    v_exp_f32 v12, v12
    v_exp_f32 v13, v13
    v_exp_f32 v14, v14
    v_exp_f32 v15, v15
    v_exp_f32 v16, v16
    v_exp_f32 v17, v17
    v_exp_f32 v18, v18
    v_exp_f32 v19, v19
    v_exp_f32 v20, v20
    v_exp_f32 v21, v21
    v_exp_f32 v22, v22
    v_exp_f32 v23, v23
    v_exp_f32 v24, v24
    v_exp_f32 v25, v25
    v_exp_f32 v26, v26
    v_exp_f32 v27, v27
    v_exp_f32 v28, v28
    v_exp_f32 v29, v29
    v_exp_f32 v30, v30
    v_exp_f32 v31, v31
    s_nop 0
    v_add_f32 v62, v0, v1
    v_add_f32 v62, v62, v2
    v_add_f32 v62, v62, v3
    v_add_f32 v62, v62, v4
    v_add_f32 v62, v62, v5
    v_add_f32 v62, v62, v6
    v_add_f32 v62, v62, v7
    v_add_f32 v62, v62, v8
    v_add_f32 v62, v62, v9
    v_add_f32 v62, v62, v10
    v_add_f32 v62, v62, v11
    v_add_f32 v62, v62, v12
    v_add_f32 v62, v62, v13
    v_add_f32 v62, v62, v14
    v_add_f32 v62, v62, v15
    v_add_f32 v62, v62, v16
    v_add_f32 v62, v62, v17
    v_add_f32 v62, v62, v18
    v_add_f32 v62, v62, v19
    v_add_f32 v62, v62, v20
    v_add_f32 v62, v62, v21
    v_add_f32 v62, v62, v22
    v_add_f32 v62, v62, v23
    v_add_f32 v62, v62, v24
    v_add_f32 v62, v62, v25
    v_add_f32 v62, v62, v26
    v_add_f32 v62, v62, v27
    v_add_f32 v62, v62, v28
    v_add_f32 v62, v62, v29
    v_add_f32 v62, v62, v30
    v_add_f32 v62, v62, v31
    ds_bpermute_b32 v63, v60, v62
    s_waitcnt lgkmcnt(0)
    v_add_f32 v62, v62, v63
    ds_bpermute_b32 v63, v61, v62
    s_waitcnt lgkmcnt(0)
    v_add_f32 v62, v62, v63
    v_cvt_pk_bf16_f32 v32, v0, v1
    v_cvt_pk_bf16_f32 v33, v2, v3
    v_cvt_pk_bf16_f32 v34, v4, v5
    v_cvt_pk_bf16_f32 v35, v6, v7
    v_cvt_pk_bf16_f32 v36, v8, v9
    v_cvt_pk_bf16_f32 v37, v10, v11
    v_cvt_pk_bf16_f32 v38, v12, v13
    v_cvt_pk_bf16_f32 v39, v14, v15
    v_cvt_pk_bf16_f32 v40, v16, v17
    v_cvt_pk_bf16_f32 v41, v18, v19
    v_cvt_pk_bf16_f32 v42, v20, v21
    v_cvt_pk_bf16_f32 v43, v22, v23
    v_cvt_pk_bf16_f32 v44, v24, v25
    v_cvt_pk_bf16_f32 v45, v26, v27
    v_cvt_pk_bf16_f32 v46, v28, v29
    v_cvt_pk_bf16_f32 v47, v30, v31
    s_mov_b32 s59, 0x05040100
    s_mov_b32 s60, 0x07060302
    s_waitcnt vmcnt(16)
    v_perm_b32 v48, v68, v64, s59
    v_perm_b32 v49, v76, v72, s59
    v_perm_b32 v50, v84, v80, s59
    v_perm_b32 v51, v92, v88, s59
    s_nop 1
    v_mfma_f32_16x16x32_bf16 a[64:67], v[32:35], v[48:51], 0
    v_perm_b32 v52, v68, v64, s60
    v_perm_b32 v53, v76, v72, s60
    v_perm_b32 v54, v84, v80, s60
    v_perm_b32 v55, v92, v88, s60
    s_nop 1
    v_mfma_f32_16x16x32_bf16 a[68:71], v[32:35], v[52:55], 0
    v_perm_b32 v48, v69, v65, s59
    v_perm_b32 v49, v77, v73, s59
    v_perm_b32 v50, v85, v81, s59
    v_perm_b32 v51, v93, v89, s59
    s_nop 1
    v_mfma_f32_16x16x32_bf16 a[72:75], v[32:35], v[48:51], 0
    v_perm_b32 v52, v69, v65, s60
    v_perm_b32 v53, v77, v73, s60
    v_perm_b32 v54, v85, v81, s60
    v_perm_b32 v55, v93, v89, s60
    s_nop 1
    v_mfma_f32_16x16x32_bf16 a[76:79], v[32:35], v[52:55], 0
    v_perm_b32 v48, v70, v66, s59
    v_perm_b32 v49, v78, v74, s59
    v_perm_b32 v50, v86, v82, s59
    v_perm_b32 v51, v94, v90, s59
    s_nop 1
    v_mfma_f32_16x16x32_bf16 a[80:83], v[32:35], v[48:51], 0
    v_perm_b32 v52, v70, v66, s60
    v_perm_b32 v53, v78, v74, s60
    v_perm_b32 v54, v86, v82, s60
    v_perm_b32 v55, v94, v90, s60
    s_nop 1
    v_mfma_f32_16x16x32_bf16 a[84:87], v[32:35], v[52:55], 0
    v_perm_b32 v48, v71, v67, s59
    v_perm_b32 v49, v79, v75, s59
    v_perm_b32 v50, v87, v83, s59
    v_perm_b32 v51, v95, v91, s59
    s_nop 1
    v_mfma_f32_16x16x32_bf16 a[88:91], v[32:35], v[48:51], 0
    v_perm_b32 v52, v71, v67, s60
    v_perm_b32 v53, v79, v75, s60
    v_perm_b32 v54, v87, v83, s60
    v_perm_b32 v55, v95, v91, s60
    s_nop 1
    v_mfma_f32_16x16x32_bf16 a[92:95], v[32:35], v[52:55], 0
    v_perm_b32 v48, v100, v96, s59
    v_perm_b32 v49, v108, v104, s59
    v_perm_b32 v50, v116, v112, s59
    v_perm_b32 v51, v124, v120, s59
    s_nop 1
    v_mfma_f32_16x16x32_bf16 a[64:67], v[36:39], v[48:51], a[64:67]
    v_perm_b32 v52, v100, v96, s60
    v_perm_b32 v53, v108, v104, s60
    v_perm_b32 v54, v116, v112, s60
    v_perm_b32 v55, v124, v120, s60
    s_nop 1
    v_mfma_f32_16x16x32_bf16 a[68:71], v[36:39], v[52:55], a[68:71]
    v_perm_b32 v48, v101, v97, s59
    v_perm_b32 v49, v109, v105, s59
    v_perm_b32 v50, v117, v113, s59
    v_perm_b32 v51, v125, v121, s59
    s_nop 1
    v_mfma_f32_16x16x32_bf16 a[72:75], v[36:39], v[48:51], a[72:75]
    v_perm_b32 v52, v101, v97, s60
    v_perm_b32 v53, v109, v105, s60
    v_perm_b32 v54, v117, v113, s60
    v_perm_b32 v55, v125, v121, s60
    s_nop 1
    v_mfma_f32_16x16x32_bf16 a[76:79], v[36:39], v[52:55], a[76:79]
    v_perm_b32 v48, v102, v98, s59
    v_perm_b32 v49, v110, v106, s59
    v_perm_b32 v50, v118, v114, s59
    v_perm_b32 v51, v126, v122, s59
    s_nop 1
    v_mfma_f32_16x16x32_bf16 a[80:83], v[36:39], v[48:51], a[80:83]
    v_perm_b32 v52, v102, v98, s60
    v_perm_b32 v53, v110, v106, s60
    v_perm_b32 v54, v118, v114, s60
    v_perm_b32 v55, v126, v122, s60
    s_nop 1
    v_mfma_f32_16x16x32_bf16 a[84:87], v[36:39], v[52:55], a[84:87]
    v_perm_b32 v48, v103, v99, s59
    v_perm_b32 v49, v111, v107, s59
    v_perm_b32 v50, v119, v115, s59
    v_perm_b32 v51, v127, v123, s59
    s_nop 1
    v_mfma_f32_16x16x32_bf16 a[88:91], v[36:39], v[48:51], a[88:91]
    v_perm_b32 v52, v103, v99, s60
    v_perm_b32 v53, v111, v107, s60
    v_perm_b32 v54, v119, v115, s60
    v_perm_b32 v55, v127, v123, s60
    s_nop 1
    v_mfma_f32_16x16x32_bf16 a[92:95], v[36:39], v[52:55], a[92:95]
    s_waitcnt vmcnt(0)
    v_accvgpr_read_b32 v64, a0
    v_accvgpr_read_b32 v65, a1
    v_accvgpr_read_b32 v66, a2
    v_accvgpr_read_b32 v67, a3
    v_accvgpr_read_b32 v68, a4
    v_accvgpr_read_b32 v69, a5
    v_accvgpr_read_b32 v70, a6
    v_accvgpr_read_b32 v71, a7
    v_accvgpr_read_b32 v72, a8
    v_accvgpr_read_b32 v73, a9
    v_accvgpr_read_b32 v74, a10
    v_accvgpr_read_b32 v75, a11
    v_accvgpr_read_b32 v76, a12
    v_accvgpr_read_b32 v77, a13
    v_accvgpr_read_b32 v78, a14
    v_accvgpr_read_b32 v79, a15
    v_accvgpr_read_b32 v80, a16
    v_accvgpr_read_b32 v81, a17
    v_accvgpr_read_b32 v82, a18
    v_accvgpr_read_b32 v83, a19
    v_accvgpr_read_b32 v84, a20
    v_accvgpr_read_b32 v85, a21
    v_accvgpr_read_b32 v86, a22
    v_accvgpr_read_b32 v87, a23
    v_accvgpr_read_b32 v88, a24
    v_accvgpr_read_b32 v89, a25
    v_accvgpr_read_b32 v90, a26
    v_accvgpr_read_b32 v91, a27
    v_accvgpr_read_b32 v92, a28
    v_accvgpr_read_b32 v93, a29
    v_accvgpr_read_b32 v94, a30
    v_accvgpr_read_b32 v95, a31
    v_accvgpr_read_b32 v96, a32
    v_accvgpr_read_b32 v97, a33
    v_accvgpr_read_b32 v98, a34
    v_accvgpr_read_b32 v99, a35
    v_accvgpr_read_b32 v100, a36
    v_accvgpr_read_b32 v101, a37
    v_accvgpr_read_b32 v102, a38
    v_accvgpr_read_b32 v103, a39
    v_accvgpr_read_b32 v104, a40
    v_accvgpr_read_b32 v105, a41
    v_accvgpr_read_b32 v106, a42
    v_accvgpr_read_b32 v107, a43
    v_accvgpr_read_b32 v108, a44
    v_accvgpr_read_b32 v109, a45
    v_accvgpr_read_b32 v110, a46
    v_accvgpr_read_b32 v111, a47
    v_accvgpr_read_b32 v112, a48
    v_accvgpr_read_b32 v113, a49
    v_accvgpr_read_b32 v114, a50
    v_accvgpr_read_b32 v115, a51
    v_accvgpr_read_b32 v116, a52
    v_accvgpr_read_b32 v117, a53
    v_accvgpr_read_b32 v118, a54
    v_accvgpr_read_b32 v119, a55
    v_accvgpr_read_b32 v120, a56
    v_accvgpr_read_b32 v121, a57
    v_accvgpr_read_b32 v122, a58
    v_accvgpr_read_b32 v123, a59
    v_accvgpr_read_b32 v124, a60
    v_accvgpr_read_b32 v125, a61
    v_accvgpr_read_b32 v126, a62
    v_accvgpr_read_b32 v127, a63
    s_nop 1
    v_perm_b32 v48, v68, v64, s59
    v_perm_b32 v49, v76, v72, s59
    v_perm_b32 v50, v84, v80, s59
    v_perm_b32 v51, v92, v88, s59
    s_nop 1
    v_mfma_f32_16x16x32_bf16 a[64:67], v[40:43], v[48:51], a[64:67]
    v_perm_b32 v52, v68, v64, s60
    v_perm_b32 v53, v76, v72, s60
    v_perm_b32 v54, v84, v80, s60
    v_perm_b32 v55, v92, v88, s60
    s_nop 1
    v_mfma_f32_16x16x32_bf16 a[68:71], v[40:43], v[52:55], a[68:71]
    v_perm_b32 v48, v69, v65, s59
    v_perm_b32 v49, v77, v73, s59
    v_perm_b32 v50, v85, v81, s59
    v_perm_b32 v51, v93, v89, s59
    s_nop 1
    v_mfma_f32_16x16x32_bf16 a[72:75], v[40:43], v[48:51], a[72:75]
    v_perm_b32 v52, v69, v65, s60
    v_perm_b32 v53, v77, v73, s60
    v_perm_b32 v54, v85, v81, s60
    v_perm_b32 v55, v93, v89, s60
    s_nop 1
    v_mfma_f32_16x16x32_bf16 a[76:79], v[40:43], v[52:55], a[76:79]
    v_perm_b32 v48, v70, v66, s59
    v_perm_b32 v49, v78, v74, s59
    v_perm_b32 v50, v86, v82, s59
    v_perm_b32 v51, v94, v90, s59
    s_nop 1
    v_mfma_f32_16x16x32_bf16 a[80:83], v[40:43], v[48:51], a[80:83]
    v_perm_b32 v52, v70, v66, s60
    v_perm_b32 v53, v78, v74, s60
    v_perm_b32 v54, v86, v82, s60
    v_perm_b32 v55, v94, v90, s60
    s_nop 1
    v_mfma_f32_16x16x32_bf16 a[84:87], v[40:43], v[52:55], a[84:87]
    v_perm_b32 v48, v71, v67, s59
    v_perm_b32 v49, v79, v75, s59
    v_perm_b32 v50, v87, v83, s59
    v_perm_b32 v51, v95, v91, s59
    s_nop 1
    v_mfma_f32_16x16x32_bf16 a[88:91], v[40:43], v[48:51], a[88:91]
    v_perm_b32 v52, v71, v67, s60
    v_perm_b32 v53, v79, v75, s60
    v_perm_b32 v54, v87, v83, s60
    v_perm_b32 v55, v95, v91, s60
    s_nop 1
    v_mfma_f32_16x16x32_bf16 a[92:95], v[40:43], v[52:55], a[92:95]
    v_perm_b32 v48, v100, v96, s59
    v_perm_b32 v49, v108, v104, s59
    v_perm_b32 v50, v116, v112, s59
    v_perm_b32 v51, v124, v120, s59
    s_nop 1
    v_mfma_f32_16x16x32_bf16 a[64:67], v[44:47], v[48:51], a[64:67]
    v_perm_b32 v52, v100, v96, s60
    v_perm_b32 v53, v108, v104, s60
    v_perm_b32 v54, v116, v112, s60
    v_perm_b32 v55, v124, v120, s60
    s_nop 1
    v_mfma_f32_16x16x32_bf16 a[68:71], v[44:47], v[52:55], a[68:71]
    v_perm_b32 v48, v101, v97, s59
    v_perm_b32 v49, v109, v105, s59
    v_perm_b32 v50, v117, v113, s59
    v_perm_b32 v51, v125, v121, s59
    s_nop 1
    v_mfma_f32_16x16x32_bf16 a[72:75], v[44:47], v[48:51], a[72:75]
    v_perm_b32 v52, v101, v97, s60
    v_perm_b32 v53, v109, v105, s60
    v_perm_b32 v54, v117, v113, s60
    v_perm_b32 v55, v125, v121, s60
    s_nop 1
    v_mfma_f32_16x16x32_bf16 a[76:79], v[44:47], v[52:55], a[76:79]
    v_perm_b32 v48, v102, v98, s59
    v_perm_b32 v49, v110, v106, s59
    v_perm_b32 v50, v118, v114, s59
    v_perm_b32 v51, v126, v122, s59
    s_nop 1
    v_mfma_f32_16x16x32_bf16 a[80:83], v[44:47], v[48:51], a[80:83]
    v_perm_b32 v52, v102, v98, s60
    v_perm_b32 v53, v110, v106, s60
    v_perm_b32 v54, v118, v114, s60
    v_perm_b32 v55, v126, v122, s60
    s_nop 1
    v_mfma_f32_16x16x32_bf16 a[84:87], v[44:47], v[52:55], a[84:87]
    v_perm_b32 v48, v103, v99, s59
    v_perm_b32 v49, v111, v107, s59
    v_perm_b32 v50, v119, v115, s59
    v_perm_b32 v51, v127, v123, s59
    s_nop 1
    v_mfma_f32_16x16x32_bf16 a[88:91], v[44:47], v[48:51], a[88:91]
    v_perm_b32 v52, v103, v99, s60
    v_perm_b32 v53, v111, v107, s60
    v_perm_b32 v54, v119, v115, s60
    v_perm_b32 v55, v127, v123, s60
    s_nop 1
    v_mfma_f32_16x16x32_bf16 a[92:95], v[44:47], v[52:55], a[92:95]
    s_nop 7
    s_nop 1
    v_accvgpr_read_b32 v64, a64
    v_accvgpr_read_b32 v72, a65
    v_accvgpr_read_b32 v65, a68
    v_accvgpr_read_b32 v73, a69
    v_accvgpr_read_b32 v66, a72
    v_accvgpr_read_b32 v74, a73
    v_accvgpr_read_b32 v67, a76
    v_accvgpr_read_b32 v75, a77
    v_accvgpr_read_b32 v68, a80
    v_accvgpr_read_b32 v76, a81
    v_accvgpr_read_b32 v69, a84
    v_accvgpr_read_b32 v77, a85
    v_accvgpr_read_b32 v70, a88
    v_accvgpr_read_b32 v78, a89
    v_accvgpr_read_b32 v71, a92
    v_accvgpr_read_b32 v79, a93
    s_mul_i32 s53, s3, 1056
    s_add_u32 s53, s53, 1024
    v_lshlrev_b32 v59, 5, v56
    v_add_u32 v59, s53, v59
    v_cmp_gt_u32 vcc, 16, v56
    s_and_saveexec_b64 s[56:57], vcc
    ds_write_b128 v59, v[64:67]
    ds_write_b128 v59, v[68:71] offset:16
    ds_write_b128 v59, v[72:75] offset:528
    ds_write_b128 v59, v[76:79] offset:544
    s_mov_b64 exec, s[56:57]
    v_mul_u32_u24 v60, 528, v56
    v_add_u32 v60, s53, v60
    v_cmp_gt_u32 vcc, 2, v56
    s_and_saveexec_b64 s[56:57], vcc
    ds_write_b32 v60, v57 offset:512
    ds_write_b32 v60, v62 offset:516
    s_mov_b64 exec, s[56:57]
    s_waitcnt lgkmcnt(0)
    v_mov_b32 v62, 36
    v_mov_b32 v63, 1
    s_mov_b64 exec, 1
    ds_add_u32 v62, v63
    s_mov_b64 exec, -1
SB_4:
    ds_read_b32 v63, v62
    s_waitcnt lgkmcnt(0)
    v_readfirstlane_b32 s90, v63
    s_cmp_ge_u32 s90, 4
    s_cbranch_scc1 SB_4d
    s_sleep 1
    s_branch SB_4
SB_4d:
    s_lshl_b32 s53, s3, 6
    v_add_u32 v0, s53, v56
    v_lshrrev_b32 v1, 7, v0
    v_and_b32 v2, 127, v0
    v_mul_u32_u24 v3, 528, v1
    v_lshl_add_u32 v4, v2, 2, v3
    ds_read_b32 v8, v3 offset:1536
    ds_read_b32 v12, v3 offset:1540
    ds_read_b32 v16, v4 offset:1024
    ds_read_b32 v9, v3 offset:2592
    ds_read_b32 v13, v3 offset:2596
    ds_read_b32 v17, v4 offset:2080
    ds_read_b32 v10, v3 offset:3648
    ds_read_b32 v14, v3 offset:3652
    ds_read_b32 v18, v4 offset:3136
    ds_read_b32 v11, v3 offset:4704
    ds_read_b32 v15, v3 offset:4708
    ds_read_b32 v19, v4 offset:4192
    s_waitcnt lgkmcnt(0)
    v_max3_f32 v20, v8, v9, v10
    v_max_f32 v20, v20, v11
    v_sub_f32 v8, v8, v20
    v_sub_f32 v9, v9, v20
    v_sub_f32 v10, v10, v20
    v_sub_f32 v11, v11, v20
    v_exp_f32 v8, v8
    v_exp_f32 v9, v9
    v_exp_f32 v10, v10
    v_exp_f32 v11, v11
    s_nop 0
    v_mul_f32 v21, v8, v12
    v_mul_f32 v22, v8, v16
    v_fmac_f32 v21, v9, v13
    v_fmac_f32 v22, v9, v17
    v_fmac_f32 v21, v10, v14
    v_fmac_f32 v22, v10, v18
    v_fmac_f32 v21, v11, v15
    v_fmac_f32 v22, v11, v19
    s_lshr_b32 s53, s2, 3
    s_lshl_b32 s53, s53, 4
    s_and_b32 s54, s2, 7
    s_add_u32 s53, s53, s54
    s_mul_i32 s53, s53, 528
    s_add_u32 s53, s53, 131072
    v_mul_u32_u24 v5, 4224, v1
    v_lshl_add_u32 v6, v2, 2, v5
    buffer_store_dword v22, v6, s[32:35], s53 offen sc1
    v_cmp_eq_u32 vcc, 0, v2
    s_and_saveexec_b64 s[56:57], vcc
    buffer_store_dword v20, v5, s[32:35], s53 offen offset:512 sc1
    buffer_store_dword v21, v5, s[32:35], s53 offen offset:516 sc1
    s_mov_b64 exec, s[56:57]
    s_waitcnt vmcnt(0)
    s_waitcnt lgkmcnt(0)
    v_mov_b32 v62, 40
    v_mov_b32 v63, 1
    s_mov_b64 exec, 1
    ds_add_u32 v62, v63
    s_mov_b64 exec, -1
SB_5:
    ds_read_b32 v63, v62
    s_waitcnt lgkmcnt(0)
    v_readfirstlane_b32 s90, v63
    s_cmp_ge_u32 s90, 4
    s_cbranch_scc1 SB_5d
    s_sleep 1
    s_branch SB_5
SB_5d:
    s_cmp_lg_u32 s3, 0
    s_cbranch_scc1 L_end
    v_mov_b32 v62, 20
    ds_read_b32 v63, v62
    s_bfe_u32 s53, s2, 0x30004
    s_lshl_b32 s53, s53, 7
    s_lshr_b32 s54, s2, 7
    s_lshl_b32 s54, s54, 4
    s_and_b32 s55, s2, 15
    s_add_u32 s54, s54, s55
    s_lshl_b32 s54, s54, 2
    s_add_u32 s53, s53, s54
    s_add_u32 s53, s53, 12595200
    s_waitcnt lgkmcnt(0)
    v_readfirstlane_b32 s89, v63
    v_mov_b32 v62, s53
    v_mov_b32 v63, s89
    s_mov_b64 exec, 1
    buffer_store_dword v63, v62, s[32:35], 0 offen sc1
    s_mov_b64 exec, -1
    s_branch L_end
L_helper:
    s_setprio 3
    v_and_b32 v0, 255, v0
    s_sub_u32 s3, s3, 4
    s_and_b32 s53, s2, 127
    s_lshr_b32 s61, s53, 2
    s_and_b32 s62, s53, 3
    s_cmp_lg_u32 s3, 0
    s_cbranch_scc1 L_h_noep
    s_memrealtime s[92:93]
    v_mov_b32 v124, 0
    s_waitcnt lgkmcnt(0)
    s_or_b32 s92, s92, 1
    v_mov_b32 v122, s92
    v_mov_b32 v123, 0
    s_mov_b64 exec, 1
    buffer_atomic_cmpswap v[122:123], v124, s[36:39], 0 offen sc0
    s_mov_b64 exec, -1
L_h_noep:
    s_cmp_ge_u32 s2, 128
    s_cbranch_scc1 L_h_b
    s_mov_b32 s40, s4
    s_mov_b32 s41, s5
    s_mov_b32 s44, s10
    s_mov_b32 s45, s11
    s_mov_b32 s52, 0
    s_mov_b32 s42, 2304
    s_mov_b32 s43, 0x00020000
    s_mov_b32 s46, 4718592
    s_mov_b32 s47, 0x00020000
    s_and_b32 s53, s2, 127
    v_and_b32 v1, 3, v0
    v_lshrrev_b32 v2, 2, v0
    v_lshlrev_b32 v3, 13, v2
    v_lshl_add_u32 v3, v1, 4, v3
    s_lshl_b32 s54, s53, 6
    v_add_u32 v3, s54, v3
    v_lshlrev_b32 v4, 1, v2
    s_mov_b32 s55, 0
    buffer_load_dwordx4 v[8:11], v3, s[44:47], s55 offen
    s_mov_b32 s55, 524288
    buffer_load_dwordx4 v[12:15], v3, s[44:47], s55 offen
    s_mov_b32 s55, 1048576
    buffer_load_dwordx4 v[16:19], v3, s[44:47], s55 offen
    s_mov_b32 s55, 1572864
    buffer_load_dwordx4 v[20:23], v3, s[44:47], s55 offen
    s_mov_b32 s55, 2097152
    buffer_load_dwordx4 v[24:27], v3, s[44:47], s55 offen
    s_mov_b32 s55, 2621440
    buffer_load_dwordx4 v[28:31], v3, s[44:47], s55 offen
    s_mov_b32 s55, 3145728
    buffer_load_dwordx4 v[32:35], v3, s[44:47], s55 offen
    s_mov_b32 s55, 3670016
    buffer_load_dwordx4 v[36:39], v3, s[44:47], s55 offen
    s_mov_b32 s55, 4194304
    buffer_load_dwordx4 v[40:43], v3, s[44:47], s55 offen
    buffer_load_ushort v48, v4, s[40:43], 0 offen offset:0
    buffer_load_ushort v58, v4, s[40:43], 0 offen offset:1152
    buffer_load_ushort v49, v4, s[40:43], 0 offen offset:128
    buffer_load_ushort v59, v4, s[40:43], 0 offen offset:1280
    buffer_load_ushort v50, v4, s[40:43], 0 offen offset:256
    buffer_load_ushort v60, v4, s[40:43], 0 offen offset:1408
    buffer_load_ushort v51, v4, s[40:43], 0 offen offset:384
    buffer_load_ushort v61, v4, s[40:43], 0 offen offset:1536
    buffer_load_ushort v52, v4, s[40:43], 0 offen offset:512
    buffer_load_ushort v62, v4, s[40:43], 0 offen offset:1664
    buffer_load_ushort v53, v4, s[40:43], 0 offen offset:640
    buffer_load_ushort v63, v4, s[40:43], 0 offen offset:1792
    buffer_load_ushort v54, v4, s[40:43], 0 offen offset:768
    buffer_load_ushort v64, v4, s[40:43], 0 offen offset:1920
    buffer_load_ushort v55, v4, s[40:43], 0 offen offset:896
    buffer_load_ushort v65, v4, s[40:43], 0 offen offset:2048
    buffer_load_ushort v56, v4, s[40:43], 0 offen offset:1024
    buffer_load_ushort v66, v4, s[40:43], 0 offen offset:2176
    s_setprio 0
    s_cmp_lg_u32 s3, 0
    s_cbranch_scc1 EP_6
    s_waitcnt vmcnt(27)
    v_readfirstlane_b32 s89, v122
    s_cmp_eq_u32 s89, 0
    s_cselect_b32 s89, s92, s89
    v_mov_b32 v122, 20
    v_mov_b32 v123, s89
    ds_write_b32 v122, v123
EP_6:
    v_mov_b32 v70, 0
    v_mov_b32 v71, 0
    v_mov_b32 v72, 0
    v_mov_b32 v73, 0
    v_mov_b32 v74, 0
    v_mov_b32 v75, 0
    v_mov_b32 v76, 0
    v_mov_b32 v77, 0
    v_mov_b32 v78, 0
    v_mov_b32 v79, 0
    v_mov_b32 v80, 0
    v_mov_b32 v81, 0
    v_mov_b32 v82, 0
    v_mov_b32 v83, 0
    v_mov_b32 v84, 0
    v_mov_b32 v85, 0
    s_waitcnt vmcnt(0)
    v_lshlrev_b32 v48, 16, v48
    v_lshlrev_b32 v58, 16, v58
    v_lshlrev_b32 v5, 16, v8
    v_and_b32 v6, 0xffff0000, v8
    v_fmac_f32 v70, v5, v48
    v_fmac_f32 v71, v6, v48
    v_fmac_f32 v78, v5, v58
    v_fmac_f32 v79, v6, v58
    v_lshlrev_b32 v5, 16, v9
    v_and_b32 v6, 0xffff0000, v9
    v_fmac_f32 v72, v5, v48
    v_fmac_f32 v73, v6, v48
    v_fmac_f32 v80, v5, v58
    v_fmac_f32 v81, v6, v58
    v_lshlrev_b32 v5, 16, v10
    v_and_b32 v6, 0xffff0000, v10
    v_fmac_f32 v74, v5, v48
    v_fmac_f32 v75, v6, v48
    v_fmac_f32 v82, v5, v58
    v_fmac_f32 v83, v6, v58
    v_lshlrev_b32 v5, 16, v11
    v_and_b32 v6, 0xffff0000, v11
    v_fmac_f32 v76, v5, v48
    v_fmac_f32 v77, v6, v48
    v_fmac_f32 v84, v5, v58
    v_fmac_f32 v85, v6, v58
    v_lshlrev_b32 v49, 16, v49
    v_lshlrev_b32 v59, 16, v59
    v_lshlrev_b32 v5, 16, v12
    v_and_b32 v6, 0xffff0000, v12
    v_fmac_f32 v70, v5, v49
    v_fmac_f32 v71, v6, v49
    v_fmac_f32 v78, v5, v59
    v_fmac_f32 v79, v6, v59
    v_lshlrev_b32 v5, 16, v13
    v_and_b32 v6, 0xffff0000, v13
    v_fmac_f32 v72, v5, v49
    v_fmac_f32 v73, v6, v49
    v_fmac_f32 v80, v5, v59
    v_fmac_f32 v81, v6, v59
    v_lshlrev_b32 v5, 16, v14
    v_and_b32 v6, 0xffff0000, v14
    v_fmac_f32 v74, v5, v49
    v_fmac_f32 v75, v6, v49
    v_fmac_f32 v82, v5, v59
    v_fmac_f32 v83, v6, v59
    v_lshlrev_b32 v5, 16, v15
    v_and_b32 v6, 0xffff0000, v15
    v_fmac_f32 v76, v5, v49
    v_fmac_f32 v77, v6, v49
    v_fmac_f32 v84, v5, v59
    v_fmac_f32 v85, v6, v59
    v_lshlrev_b32 v50, 16, v50
    v_lshlrev_b32 v60, 16, v60
    v_lshlrev_b32 v5, 16, v16
    v_and_b32 v6, 0xffff0000, v16
    v_fmac_f32 v70, v5, v50
    v_fmac_f32 v71, v6, v50
    v_fmac_f32 v78, v5, v60
    v_fmac_f32 v79, v6, v60
    v_lshlrev_b32 v5, 16, v17
    v_and_b32 v6, 0xffff0000, v17
    v_fmac_f32 v72, v5, v50
    v_fmac_f32 v73, v6, v50
    v_fmac_f32 v80, v5, v60
    v_fmac_f32 v81, v6, v60
    v_lshlrev_b32 v5, 16, v18
    v_and_b32 v6, 0xffff0000, v18
    v_fmac_f32 v74, v5, v50
    v_fmac_f32 v75, v6, v50
    v_fmac_f32 v82, v5, v60
    v_fmac_f32 v83, v6, v60
    v_lshlrev_b32 v5, 16, v19
    v_and_b32 v6, 0xffff0000, v19
    v_fmac_f32 v76, v5, v50
    v_fmac_f32 v77, v6, v50
    v_fmac_f32 v84, v5, v60
    v_fmac_f32 v85, v6, v60
    v_lshlrev_b32 v51, 16, v51
    v_lshlrev_b32 v61, 16, v61
    v_lshlrev_b32 v5, 16, v20
    v_and_b32 v6, 0xffff0000, v20
    v_fmac_f32 v70, v5, v51
    v_fmac_f32 v71, v6, v51
    v_fmac_f32 v78, v5, v61
    v_fmac_f32 v79, v6, v61
    v_lshlrev_b32 v5, 16, v21
    v_and_b32 v6, 0xffff0000, v21
    v_fmac_f32 v72, v5, v51
    v_fmac_f32 v73, v6, v51
    v_fmac_f32 v80, v5, v61
    v_fmac_f32 v81, v6, v61
    v_lshlrev_b32 v5, 16, v22
    v_and_b32 v6, 0xffff0000, v22
    v_fmac_f32 v74, v5, v51
    v_fmac_f32 v75, v6, v51
    v_fmac_f32 v82, v5, v61
    v_fmac_f32 v83, v6, v61
    v_lshlrev_b32 v5, 16, v23
    v_and_b32 v6, 0xffff0000, v23
    v_fmac_f32 v76, v5, v51
    v_fmac_f32 v77, v6, v51
    v_fmac_f32 v84, v5, v61
    v_fmac_f32 v85, v6, v61
    v_lshlrev_b32 v52, 16, v52
    v_lshlrev_b32 v62, 16, v62
    v_lshlrev_b32 v5, 16, v24
    v_and_b32 v6, 0xffff0000, v24
    v_fmac_f32 v70, v5, v52
    v_fmac_f32 v71, v6, v52
    v_fmac_f32 v78, v5, v62
    v_fmac_f32 v79, v6, v62
    v_lshlrev_b32 v5, 16, v25
    v_and_b32 v6, 0xffff0000, v25
    v_fmac_f32 v72, v5, v52
    v_fmac_f32 v73, v6, v52
    v_fmac_f32 v80, v5, v62
    v_fmac_f32 v81, v6, v62
    v_lshlrev_b32 v5, 16, v26
    v_and_b32 v6, 0xffff0000, v26
    v_fmac_f32 v74, v5, v52
    v_fmac_f32 v75, v6, v52
    v_fmac_f32 v82, v5, v62
    v_fmac_f32 v83, v6, v62
    v_lshlrev_b32 v5, 16, v27
    v_and_b32 v6, 0xffff0000, v27
    v_fmac_f32 v76, v5, v52
    v_fmac_f32 v77, v6, v52
    v_fmac_f32 v84, v5, v62
    v_fmac_f32 v85, v6, v62
    v_lshlrev_b32 v53, 16, v53
    v_lshlrev_b32 v63, 16, v63
    v_lshlrev_b32 v5, 16, v28
    v_and_b32 v6, 0xffff0000, v28
    v_fmac_f32 v70, v5, v53
    v_fmac_f32 v71, v6, v53
    v_fmac_f32 v78, v5, v63
    v_fmac_f32 v79, v6, v63
    v_lshlrev_b32 v5, 16, v29
    v_and_b32 v6, 0xffff0000, v29
    v_fmac_f32 v72, v5, v53
    v_fmac_f32 v73, v6, v53
    v_fmac_f32 v80, v5, v63
    v_fmac_f32 v81, v6, v63
    v_lshlrev_b32 v5, 16, v30
    v_and_b32 v6, 0xffff0000, v30
    v_fmac_f32 v74, v5, v53
    v_fmac_f32 v75, v6, v53
    v_fmac_f32 v82, v5, v63
    v_fmac_f32 v83, v6, v63
    v_lshlrev_b32 v5, 16, v31
    v_and_b32 v6, 0xffff0000, v31
    v_fmac_f32 v76, v5, v53
    v_fmac_f32 v77, v6, v53
    v_fmac_f32 v84, v5, v63
    v_fmac_f32 v85, v6, v63
    v_lshlrev_b32 v54, 16, v54
    v_lshlrev_b32 v64, 16, v64
    v_lshlrev_b32 v5, 16, v32
    v_and_b32 v6, 0xffff0000, v32
    v_fmac_f32 v70, v5, v54
    v_fmac_f32 v71, v6, v54
    v_fmac_f32 v78, v5, v64
    v_fmac_f32 v79, v6, v64
    v_lshlrev_b32 v5, 16, v33
    v_and_b32 v6, 0xffff0000, v33
    v_fmac_f32 v72, v5, v54
    v_fmac_f32 v73, v6, v54
    v_fmac_f32 v80, v5, v64
    v_fmac_f32 v81, v6, v64
    v_lshlrev_b32 v5, 16, v34
    v_and_b32 v6, 0xffff0000, v34
    v_fmac_f32 v74, v5, v54
    v_fmac_f32 v75, v6, v54
    v_fmac_f32 v82, v5, v64
    v_fmac_f32 v83, v6, v64
    v_lshlrev_b32 v5, 16, v35
    v_and_b32 v6, 0xffff0000, v35
    v_fmac_f32 v76, v5, v54
    v_fmac_f32 v77, v6, v54
    v_fmac_f32 v84, v5, v64
    v_fmac_f32 v85, v6, v64
    v_lshlrev_b32 v55, 16, v55
    v_lshlrev_b32 v65, 16, v65
    v_lshlrev_b32 v5, 16, v36
    v_and_b32 v6, 0xffff0000, v36
    v_fmac_f32 v70, v5, v55
    v_fmac_f32 v71, v6, v55
    v_fmac_f32 v78, v5, v65
    v_fmac_f32 v79, v6, v65
    v_lshlrev_b32 v5, 16, v37
    v_and_b32 v6, 0xffff0000, v37
    v_fmac_f32 v72, v5, v55
    v_fmac_f32 v73, v6, v55
    v_fmac_f32 v80, v5, v65
    v_fmac_f32 v81, v6, v65
    v_lshlrev_b32 v5, 16, v38
    v_and_b32 v6, 0xffff0000, v38
    v_fmac_f32 v74, v5, v55
    v_fmac_f32 v75, v6, v55
    v_fmac_f32 v82, v5, v65
    v_fmac_f32 v83, v6, v65
    v_lshlrev_b32 v5, 16, v39
    v_and_b32 v6, 0xffff0000, v39
    v_fmac_f32 v76, v5, v55
    v_fmac_f32 v77, v6, v55
    v_fmac_f32 v84, v5, v65
    v_fmac_f32 v85, v6, v65
    v_lshlrev_b32 v56, 16, v56
    v_lshlrev_b32 v66, 16, v66
    v_lshlrev_b32 v5, 16, v40
    v_and_b32 v6, 0xffff0000, v40
    v_fmac_f32 v70, v5, v56
    v_fmac_f32 v71, v6, v56
    v_fmac_f32 v78, v5, v66
    v_fmac_f32 v79, v6, v66
    v_lshlrev_b32 v5, 16, v41
    v_and_b32 v6, 0xffff0000, v41
    v_fmac_f32 v72, v5, v56
    v_fmac_f32 v73, v6, v56
    v_fmac_f32 v80, v5, v66
    v_fmac_f32 v81, v6, v66
    v_lshlrev_b32 v5, 16, v42
    v_and_b32 v6, 0xffff0000, v42
    v_fmac_f32 v74, v5, v56
    v_fmac_f32 v75, v6, v56
    v_fmac_f32 v82, v5, v66
    v_fmac_f32 v83, v6, v66
    v_lshlrev_b32 v5, 16, v43
    v_and_b32 v6, 0xffff0000, v43
    v_fmac_f32 v76, v5, v56
    v_fmac_f32 v77, v6, v56
    v_fmac_f32 v84, v5, v66
    v_fmac_f32 v85, v6, v66
    v_lshlrev_b32 v7, 6, v0
    ds_write_b128 v7, v[70:73] offset:8192
    ds_write_b128 v7, v[74:77] offset:8208
    ds_write_b128 v7, v[78:81] offset:8224
    ds_write_b128 v7, v[82:85] offset:8240
    s_waitcnt lgkmcnt(0)
    v_mov_b32 v88, 44
    v_mov_b32 v89, 1
    s_mov_b64 exec, 1
    ds_add_u32 v88, v89
    s_mov_b64 exec, -1
SB_7:
    ds_read_b32 v89, v88
    s_waitcnt lgkmcnt(0)
    v_readfirstlane_b32 s90, v89
    s_cmp_ge_u32 s90, 4
    s_cbranch_scc1 SB_7d
    s_sleep 1
    s_branch SB_7
SB_7d:
    s_cmp_lg_u32 s3, 0
    s_cbranch_scc1 L_h_qdone
    v_lshlrev_b32 v7, 2, v0
    ds_read_b32 v8, v7 offset:8192
    ds_read_b32 v9, v7 offset:8448
    ds_read_b32 v10, v7 offset:8704
    ds_read_b32 v11, v7 offset:8960
    ds_read_b32 v12, v7 offset:9216
    ds_read_b32 v13, v7 offset:9472
    ds_read_b32 v14, v7 offset:9728
    ds_read_b32 v15, v7 offset:9984
    ds_read_b32 v16, v7 offset:10240
    ds_read_b32 v17, v7 offset:10496
    ds_read_b32 v18, v7 offset:10752
    ds_read_b32 v19, v7 offset:11008
    ds_read_b32 v20, v7 offset:11264
    ds_read_b32 v21, v7 offset:11520
    ds_read_b32 v22, v7 offset:11776
    ds_read_b32 v23, v7 offset:12032
    ds_read_b32 v24, v7 offset:12288
    ds_read_b32 v25, v7 offset:12544
    ds_read_b32 v26, v7 offset:12800
    ds_read_b32 v27, v7 offset:13056
    ds_read_b32 v28, v7 offset:13312
    ds_read_b32 v29, v7 offset:13568
    ds_read_b32 v30, v7 offset:13824
    ds_read_b32 v31, v7 offset:14080
    ds_read_b32 v32, v7 offset:14336
    ds_read_b32 v33, v7 offset:14592
    ds_read_b32 v34, v7 offset:14848
    ds_read_b32 v35, v7 offset:15104
    ds_read_b32 v36, v7 offset:15360
    ds_read_b32 v37, v7 offset:15616
    ds_read_b32 v38, v7 offset:15872
    ds_read_b32 v39, v7 offset:16128
    ds_read_b32 v40, v7 offset:16384
    ds_read_b32 v41, v7 offset:16640
    ds_read_b32 v42, v7 offset:16896
    ds_read_b32 v43, v7 offset:17152
    ds_read_b32 v44, v7 offset:17408
    ds_read_b32 v45, v7 offset:17664
    ds_read_b32 v46, v7 offset:17920
    ds_read_b32 v47, v7 offset:18176
    ds_read_b32 v48, v7 offset:18432
    ds_read_b32 v49, v7 offset:18688
    ds_read_b32 v50, v7 offset:18944
    ds_read_b32 v51, v7 offset:19200
    ds_read_b32 v52, v7 offset:19456
    ds_read_b32 v53, v7 offset:19712
    ds_read_b32 v54, v7 offset:19968
    ds_read_b32 v55, v7 offset:20224
    ds_read_b32 v56, v7 offset:20480
    ds_read_b32 v57, v7 offset:20736
    ds_read_b32 v58, v7 offset:20992
    ds_read_b32 v59, v7 offset:21248
    ds_read_b32 v60, v7 offset:21504
    ds_read_b32 v61, v7 offset:21760
    ds_read_b32 v62, v7 offset:22016
    ds_read_b32 v63, v7 offset:22272
    ds_read_b32 v64, v7 offset:22528
    ds_read_b32 v65, v7 offset:22784
    ds_read_b32 v66, v7 offset:23040
    ds_read_b32 v67, v7 offset:23296
    ds_read_b32 v68, v7 offset:23552
    ds_read_b32 v69, v7 offset:23808
    ds_read_b32 v70, v7 offset:24064
    ds_read_b32 v71, v7 offset:24320
    s_waitcnt lgkmcnt(0)
    v_add_f32 v8, v8, v40
    v_add_f32 v9, v9, v41
    v_add_f32 v10, v10, v42
    v_add_f32 v11, v11, v43
    v_add_f32 v12, v12, v44
    v_add_f32 v13, v13, v45
    v_add_f32 v14, v14, v46
    v_add_f32 v15, v15, v47
    v_add_f32 v16, v16, v48
    v_add_f32 v17, v17, v49
    v_add_f32 v18, v18, v50
    v_add_f32 v19, v19, v51
    v_add_f32 v20, v20, v52
    v_add_f32 v21, v21, v53
    v_add_f32 v22, v22, v54
    v_add_f32 v23, v23, v55
    v_add_f32 v24, v24, v56
    v_add_f32 v25, v25, v57
    v_add_f32 v26, v26, v58
    v_add_f32 v27, v27, v59
    v_add_f32 v28, v28, v60
    v_add_f32 v29, v29, v61
    v_add_f32 v30, v30, v62
    v_add_f32 v31, v31, v63
    v_add_f32 v32, v32, v64
    v_add_f32 v33, v33, v65
    v_add_f32 v34, v34, v66
    v_add_f32 v35, v35, v67
    v_add_f32 v36, v36, v68
    v_add_f32 v37, v37, v69
    v_add_f32 v38, v38, v70
    v_add_f32 v39, v39, v71
    v_add_f32 v8, v8, v24
    v_add_f32 v9, v9, v25
    v_add_f32 v10, v10, v26
    v_add_f32 v11, v11, v27
    v_add_f32 v12, v12, v28
    v_add_f32 v13, v13, v29
    v_add_f32 v14, v14, v30
    v_add_f32 v15, v15, v31
    v_add_f32 v16, v16, v32
    v_add_f32 v17, v17, v33
    v_add_f32 v18, v18, v34
    v_add_f32 v19, v19, v35
    v_add_f32 v20, v20, v36
    v_add_f32 v21, v21, v37
    v_add_f32 v22, v22, v38
    v_add_f32 v23, v23, v39
    v_add_f32 v8, v8, v16
    v_add_f32 v9, v9, v17
    v_add_f32 v10, v10, v18
    v_add_f32 v11, v11, v19
    v_add_f32 v12, v12, v20
    v_add_f32 v13, v13, v21
    v_add_f32 v14, v14, v22
    v_add_f32 v15, v15, v23
    v_add_f32 v8, v8, v12
    v_add_f32 v9, v9, v13
    v_add_f32 v10, v10, v14
    v_add_f32 v11, v11, v15
    v_add_f32 v8, v8, v10
    v_add_f32 v9, v9, v11
    v_add_f32 v8, v8, v9
    v_cvt_pk_bf16_f32 v8, v8, v8
    v_lshrrev_b32 v1, 4, v0
    v_bfe_u32 v2, v0, 3, 1
    v_and_b32 v3, 7, v0
    v_lshl_add_u32 v3, v1, 3, v3
    v_lshl_add_u32 v3, v2, 12, v3
    s_lshl_b32 s54, s53, 5
    v_add_u32 v3, s54, v3
    v_lshlrev_b32 v3, 1, v3
    buffer_store_short v8, v3, s[32:35], s52 offen sc1
    s_waitcnt vmcnt(0)
    s_lshr_b32 s54, s2, 3
    s_lshl_b32 s54, s54, 7
    s_and_b32 s55, s2, 7
    s_lshl_b32 s55, s55, 2
    s_add_u32 s54, s54, s55
    s_add_u32 s54, s54, 12582912
    v_mov_b32 v88, s54
    v_mov_b32 v89, s89
    s_mov_b64 exec, 1
    buffer_store_dword v89, v88, s[32:35], 0 offen sc1
    s_mov_b64 exec, -1
    s_waitcnt lgkmcnt(0)
    v_mov_b32 v88, 28
    v_mov_b32 v89, 1
    s_mov_b64 exec, 1
    ds_add_u32 v88, v89
    s_mov_b64 exec, -1
    v_and_b32 v56, 63, v0
    s_bfe_u32 s54, s2, 0x40003
    s_lshl_b32 s55, s54, 7
    s_add_u32 s55, s55, 12582912
    v_cmp_gt_u32 vcc, 8, v56
    v_lshlrev_b32 v88, 2, v56
    s_nop 1
    v_cndmask_b32 v88, 0, v88, vcc
GP_8:
    buffer_load_dword v89, v88, s[32:35], s55 offen sc1
    s_waitcnt vmcnt(0)
    v_cmp_ne_u32 vcc, s89, v89
    s_cmp_eq_u64 vcc, 0
    s_cbranch_scc1 GP_8d
    s_sleep 16
    s_branch GP_8
GP_8d:
    s_lshr_b32 s55, s2, 7
    s_lshl_b32 s55, s55, 13
    s_lshl_b32 s54, s54, 9
    s_add_u32 s55, s55, s54
    v_lshlrev_b32 v1, 4, v56
    v_cmp_gt_u32 vcc, 32, v56
    s_and_saveexec_b64 s[56:57], vcc
    buffer_load_dwordx4 v[8:11], v1, s[32:35], s55 offen offset:0 sc1
    s_waitcnt vmcnt(0)
    ds_write_b128 v1, v[8:11] offset:256
    s_mov_b64 exec, s[56:57]
    s_waitcnt lgkmcnt(0)
    v_mov_b32 v88, 0
    v_mov_b32 v89, 1
    s_mov_b64 exec, 1
    ds_add_u32 v88, v89
    s_mov_b64 exec, -1
L_h_qdone:
    v_and_b32 v56, 63, v0
    s_cmp_lg_u32 s3, 0
    s_cbranch_scc1 L_ab_w
    s_mov_b32 s54, 12591104
    v_lshlrev_b32 v44, 2, v56
GP_9:
    buffer_load_dword v45, v44, s[32:35], s54 offen sc1
    buffer_load_dword v46, v44, s[32:35], s54 offen offset:256 sc1
    s_waitcnt vmcnt(0)
    v_cmp_ne_u32 vcc, s89, v45
    v_cmp_ne_u32 s[96:97], s89, v46
    s_or_b64 vcc, vcc, s[96:97]
    s_cmp_eq_u64 vcc, 0
    s_cbranch_scc1 GP_9d
    s_sleep 16
    s_branch GP_9
GP_9d:
    s_waitcnt lgkmcnt(0)
    v_mov_b32 v44, 8
    v_mov_b32 v45, 1
    s_mov_b64 exec, 1
    ds_add_u32 v44, v45
    s_mov_b64 exec, -1
L_ab_w:
    v_mov_b32 v44, 8
LW_10:
    ds_read_b32 v45, v44
    s_waitcnt lgkmcnt(0)
    v_readfirstlane_b32 s90, v45
    s_cmp_ge_u32 s90, 1
    s_cbranch_scc1 LW_10d
    s_sleep 1
    s_branch LW_10
LW_10d:
    s_lshr_b32 s54, s2, 6
    s_lshl_b32 s54, s54, 15
    s_lshl_b32 s55, s3, 13
    s_add_u32 s54, s54, s55
    s_add_u32 s54, s54, 32768
    v_lshlrev_b32 v57, 4, v56
    buffer_load_dwordx4 v[64:67], v57, s[32:35], s54 offen offset:0 sc1
    buffer_load_dwordx4 v[68:71], v57, s[32:35], s54 offen offset:1024 sc1
    buffer_load_dwordx4 v[72:75], v57, s[32:35], s54 offen offset:2048 sc1
    buffer_load_dwordx4 v[76:79], v57, s[32:35], s54 offen offset:3072 sc1
    s_add_u32 s54, s54, 4096
    buffer_load_dwordx4 v[80:83], v57, s[32:35], s54 offen offset:0 sc1
    buffer_load_dwordx4 v[84:87], v57, s[32:35], s54 offen offset:1024 sc1
    buffer_load_dwordx4 v[88:91], v57, s[32:35], s54 offen offset:2048 sc1
    buffer_load_dwordx4 v[92:95], v57, s[32:35], s54 offen offset:3072 sc1
    s_mul_i32 s55, s3, 8320
    v_add_u32 v58, s55, v57
    v_add_u32 v58, 104960, v58
    s_waitcnt vmcnt(0)
    ds_write_b128 v58, v[64:67] offset:0
    ds_write_b128 v58, v[68:71] offset:1040
    ds_write_b128 v58, v[72:75] offset:2080
    ds_write_b128 v58, v[76:79] offset:3120
    ds_write_b128 v58, v[80:83] offset:4160
    ds_write_b128 v58, v[84:87] offset:5200
    ds_write_b128 v58, v[88:91] offset:6240
    ds_write_b128 v58, v[92:95] offset:7280
    v_mov_b32 v44, 4
LW_11:
    ds_read_b32 v45, v44
    s_waitcnt lgkmcnt(0)
    v_readfirstlane_b32 s90, v45
    s_cmp_ge_u32 s90, 4
    s_cbranch_scc1 LW_11d
    s_sleep 1
    s_branch LW_11
LW_11d:
    s_waitcnt lgkmcnt(0)
    v_mov_b32 v44, 48
    v_mov_b32 v45, 1
    s_mov_b64 exec, 1
    ds_add_u32 v44, v45
    s_mov_b64 exec, -1
SB_12:
    ds_read_b32 v45, v44
    s_waitcnt lgkmcnt(0)
    v_readfirstlane_b32 s90, v45
    s_cmp_ge_u32 s90, 4
    s_cbranch_scc1 SB_12d
    s_sleep 1
    s_branch SB_12
SB_12d:
    v_and_b32 v59, 15, v56
    v_bfe_u32 v60, v56, 4, 2
    s_mul_i32 s55, s3, 16640
    v_mul_u32_u24 v57, 1040, v59
    v_lshl_add_u32 v57, v60, 4, v57
    v_add_u32 v58, 104960, v57
    v_add_u32 v57, s55, v57
    v_add_u32 v57, 38400, v57
    ds_read_b128 v[8:11], v57 offset:0
    ds_read_b128 v[12:15], v58 offset:0
    ds_read_b128 v[16:19], v58 offset:16640
    s_waitcnt lgkmcnt(0)
    v_mfma_f32_16x16x32_bf16 v[0:3], v[8:11], v[12:15], 0
    v_mfma_f32_16x16x32_bf16 v[4:7], v[8:11], v[16:19], 0
    ds_read_b128 v[20:23], v57 offset:64
    ds_read_b128 v[24:27], v58 offset:64
    ds_read_b128 v[28:31], v58 offset:16704
    s_waitcnt lgkmcnt(0)
    v_mfma_f32_16x16x32_bf16 v[0:3], v[20:23], v[24:27], v[0:3]
    v_mfma_f32_16x16x32_bf16 v[4:7], v[20:23], v[28:31], v[4:7]
    ds_read_b128 v[8:11], v57 offset:128
    ds_read_b128 v[12:15], v58 offset:128
    ds_read_b128 v[16:19], v58 offset:16768
    s_waitcnt lgkmcnt(0)
    v_mfma_f32_16x16x32_bf16 v[0:3], v[8:11], v[12:15], v[0:3]
    v_mfma_f32_16x16x32_bf16 v[4:7], v[8:11], v[16:19], v[4:7]
    ds_read_b128 v[20:23], v57 offset:192
    ds_read_b128 v[24:27], v58 offset:192
    ds_read_b128 v[28:31], v58 offset:16832
    s_waitcnt lgkmcnt(0)
    v_mfma_f32_16x16x32_bf16 v[0:3], v[20:23], v[24:27], v[0:3]
    v_mfma_f32_16x16x32_bf16 v[4:7], v[20:23], v[28:31], v[4:7]
    ds_read_b128 v[8:11], v57 offset:256
    ds_read_b128 v[12:15], v58 offset:256
    ds_read_b128 v[16:19], v58 offset:16896
    s_waitcnt lgkmcnt(0)
    v_mfma_f32_16x16x32_bf16 v[0:3], v[8:11], v[12:15], v[0:3]
    v_mfma_f32_16x16x32_bf16 v[4:7], v[8:11], v[16:19], v[4:7]
    ds_read_b128 v[20:23], v57 offset:320
    ds_read_b128 v[24:27], v58 offset:320
    ds_read_b128 v[28:31], v58 offset:16960
    s_waitcnt lgkmcnt(0)
    v_mfma_f32_16x16x32_bf16 v[0:3], v[20:23], v[24:27], v[0:3]
    v_mfma_f32_16x16x32_bf16 v[4:7], v[20:23], v[28:31], v[4:7]
    ds_read_b128 v[8:11], v57 offset:384
    ds_read_b128 v[12:15], v58 offset:384
    ds_read_b128 v[16:19], v58 offset:17024
    s_waitcnt lgkmcnt(0)
    v_mfma_f32_16x16x32_bf16 v[0:3], v[8:11], v[12:15], v[0:3]
    v_mfma_f32_16x16x32_bf16 v[4:7], v[8:11], v[16:19], v[4:7]
    ds_read_b128 v[20:23], v57 offset:448
    ds_read_b128 v[24:27], v58 offset:448
    ds_read_b128 v[28:31], v58 offset:17088
    s_waitcnt lgkmcnt(0)
    v_mfma_f32_16x16x32_bf16 v[0:3], v[20:23], v[24:27], v[0:3]
    v_mfma_f32_16x16x32_bf16 v[4:7], v[20:23], v[28:31], v[4:7]
    ds_read_b128 v[8:11], v57 offset:512
    ds_read_b128 v[12:15], v58 offset:512
    ds_read_b128 v[16:19], v58 offset:17152
    s_waitcnt lgkmcnt(0)
    v_mfma_f32_16x16x32_bf16 v[0:3], v[8:11], v[12:15], v[0:3]
    v_mfma_f32_16x16x32_bf16 v[4:7], v[8:11], v[16:19], v[4:7]
    ds_read_b128 v[20:23], v57 offset:576
    ds_read_b128 v[24:27], v58 offset:576
    ds_read_b128 v[28:31], v58 offset:17216
    s_waitcnt lgkmcnt(0)
    v_mfma_f32_16x16x32_bf16 v[0:3], v[20:23], v[24:27], v[0:3]
    v_mfma_f32_16x16x32_bf16 v[4:7], v[20:23], v[28:31], v[4:7]
    ds_read_b128 v[8:11], v57 offset:640
    ds_read_b128 v[12:15], v58 offset:640
    ds_read_b128 v[16:19], v58 offset:17280
    s_waitcnt lgkmcnt(0)
    v_mfma_f32_16x16x32_bf16 v[0:3], v[8:11], v[12:15], v[0:3]
    v_mfma_f32_16x16x32_bf16 v[4:7], v[8:11], v[16:19], v[4:7]
    ds_read_b128 v[20:23], v57 offset:704
    ds_read_b128 v[24:27], v58 offset:704
    ds_read_b128 v[28:31], v58 offset:17344
    s_waitcnt lgkmcnt(0)
    v_mfma_f32_16x16x32_bf16 v[0:3], v[20:23], v[24:27], v[0:3]
    v_mfma_f32_16x16x32_bf16 v[4:7], v[20:23], v[28:31], v[4:7]
    ds_read_b128 v[8:11], v57 offset:768
    ds_read_b128 v[12:15], v58 offset:768
    ds_read_b128 v[16:19], v58 offset:17408
    s_waitcnt lgkmcnt(0)
    v_mfma_f32_16x16x32_bf16 v[0:3], v[8:11], v[12:15], v[0:3]
    v_mfma_f32_16x16x32_bf16 v[4:7], v[8:11], v[16:19], v[4:7]
    ds_read_b128 v[20:23], v57 offset:832
    ds_read_b128 v[24:27], v58 offset:832
    ds_read_b128 v[28:31], v58 offset:17472
    s_waitcnt lgkmcnt(0)
    v_mfma_f32_16x16x32_bf16 v[0:3], v[20:23], v[24:27], v[0:3]
    v_mfma_f32_16x16x32_bf16 v[4:7], v[20:23], v[28:31], v[4:7]
    ds_read_b128 v[8:11], v57 offset:896
    ds_read_b128 v[12:15], v58 offset:896
    ds_read_b128 v[16:19], v58 offset:17536
    s_waitcnt lgkmcnt(0)
    v_mfma_f32_16x16x32_bf16 v[0:3], v[8:11], v[12:15], v[0:3]
    v_mfma_f32_16x16x32_bf16 v[4:7], v[8:11], v[16:19], v[4:7]
    ds_read_b128 v[20:23], v57 offset:960
    ds_read_b128 v[24:27], v58 offset:960
    ds_read_b128 v[28:31], v58 offset:17600
    s_waitcnt lgkmcnt(0)
    v_mfma_f32_16x16x32_bf16 v[0:3], v[20:23], v[24:27], v[0:3]
    v_mfma_f32_16x16x32_bf16 v[4:7], v[20:23], v[28:31], v[4:7]
    s_nop 7
    s_nop 1
    v_max3_f32 v32, v0, v1, v2
    v_max_f32 v32, v32, v3
    v_max3_f32 v33, v4, v5, v6
    v_max_f32 v33, v33, v7
    v_xor_b32 v61, 16, v56
    v_lshlrev_b32 v61, 2, v61
    v_xor_b32 v62, 32, v56
    v_lshlrev_b32 v62, 2, v62
    ds_bpermute_b32 v34, v61, v32
    ds_bpermute_b32 v35, v61, v33
    s_waitcnt lgkmcnt(0)
    v_max_f32 v32, v32, v34
    v_max_f32 v33, v33, v35
    ds_bpermute_b32 v34, v62, v32
    ds_bpermute_b32 v35, v62, v33
    s_waitcnt lgkmcnt(0)
    v_max_f32 v32, v32, v34
    v_max_f32 v33, v33, v35
    s_lshl_b32 s54, s3, 7
    v_lshlrev_b32 v63, 2, v59
    v_add_u32 v55, s54, v63
    ds_write_b32 v55, v32 offset:37376
    ds_write_b32 v55, v33 offset:37440
    s_waitcnt lgkmcnt(0)
    v_mov_b32 v44, 52
    v_mov_b32 v45, 1
    s_mov_b64 exec, 1
    ds_add_u32 v44, v45
    s_mov_b64 exec, -1
SB_13:
    ds_read_b32 v45, v44
    s_waitcnt lgkmcnt(0)
    v_readfirstlane_b32 s90, v45
    s_cmp_ge_u32 s90, 4
    s_cbranch_scc1 SB_13d
    s_sleep 1
    s_branch SB_13
SB_13d:
    ds_read_b32 v36, v63 offset:37376
    ds_read_b32 v40, v63 offset:37440
    ds_read_b32 v37, v63 offset:37504
    ds_read_b32 v41, v63 offset:37568
    ds_read_b32 v38, v63 offset:37632
    ds_read_b32 v42, v63 offset:37696
    ds_read_b32 v39, v63 offset:37760
    ds_read_b32 v43, v63 offset:37824
    s_waitcnt lgkmcnt(0)
    v_max3_f32 v32, v36, v37, v38
    v_max_f32 v32, v32, v39
    v_max3_f32 v33, v40, v41, v42
    v_max_f32 v33, v33, v43
    s_mov_b32 s58, 0x3e0293ee
    v_mul_f32 v32, s58, v32
    v_mul_f32 v33, s58, v33
    v_fma_f32 v0, v0, s58, -v32
    v_fma_f32 v4, v4, s58, -v33
    v_fma_f32 v1, v1, s58, -v32
    v_fma_f32 v5, v5, s58, -v33
    v_fma_f32 v2, v2, s58, -v32
    v_fma_f32 v6, v6, s58, -v33
    v_fma_f32 v3, v3, s58, -v32
    v_fma_f32 v7, v7, s58, -v33
    v_exp_f32 v0, v0
    v_exp_f32 v1, v1
    v_exp_f32 v2, v2
    v_exp_f32 v3, v3
    v_exp_f32 v4, v4
    v_exp_f32 v5, v5
    v_exp_f32 v6, v6
    v_exp_f32 v7, v7
    s_nop 0
    v_add_f32 v34, v0, v1
    v_add_f32 v35, v4, v5
    v_add_f32 v34, v34, v2
    v_add_f32 v35, v35, v6
    v_add_f32 v34, v34, v3
    v_add_f32 v35, v35, v7
    ds_bpermute_b32 v36, v61, v34
    ds_bpermute_b32 v37, v61, v35
    s_waitcnt lgkmcnt(0)
    v_add_f32 v34, v34, v36
    v_add_f32 v35, v35, v37
    ds_bpermute_b32 v36, v62, v34
    ds_bpermute_b32 v37, v62, v35
    s_waitcnt lgkmcnt(0)
    v_add_f32 v34, v34, v36
    v_add_f32 v35, v35, v37
    ds_write_b32 v55, v34 offset:37888
    ds_write_b32 v55, v35 offset:37952
    v_cvt_pk_bf16_f32 v8, v0, v1
    v_cvt_pk_bf16_f32 v9, v2, v3
    v_cvt_pk_bf16_f32 v10, v4, v5
    v_cvt_pk_bf16_f32 v11, v6, v7
    v_mul_u32_u24 v54, 144, v59
    v_lshl_add_u32 v54, v60, 3, v54
    s_lshl_b32 s54, s3, 5
    v_add_u32 v54, s54, v54
    ds_write_b64 v54, v[8:9] offset:32768
    ds_write_b64 v54, v[10:11] offset:35072
    s_waitcnt lgkmcnt(0)
    v_mov_b32 v44, 56
    v_mov_b32 v45, 1
    s_mov_b64 exec, 1
    ds_add_u32 v44, v45
    s_mov_b64 exec, -1
SB_14:
    ds_read_b32 v45, v44
    s_waitcnt lgkmcnt(0)
    v_readfirstlane_b32 s90, v45
    s_cmp_ge_u32 s90, 4
    s_cbranch_scc1 SB_14d
    s_sleep 1
    s_branch SB_14
SB_14d:
    s_cmp_lg_u32 s3, 0
    s_cbranch_scc1 L_ab_noml
    v_lshlrev_b32 v53, 2, v56
    ds_read_b32 v36, v53 offset:37888
    ds_read_b32 v40, v53 offset:37376
    ds_read_b32 v37, v53 offset:38016
    ds_read_b32 v41, v53 offset:37504
    ds_read_b32 v38, v53 offset:38144
    ds_read_b32 v42, v53 offset:37632
    ds_read_b32 v39, v53 offset:38272
    ds_read_b32 v43, v53 offset:37760
    s_waitcnt lgkmcnt(0)
    v_add_f32 v36, v36, v37
    v_add_f32 v38, v38, v39
    v_add_f32 v37, v36, v38
    v_max3_f32 v36, v40, v41, v42
    v_max_f32 v36, v36, v43
    v_mul_f32 v36, s58, v36
    s_lshl_b32 s54, s2, 8
    s_add_u32 s54, s54, 8912896
    v_lshlrev_b32 v53, 3, v56
    v_cmp_gt_u32 vcc, 32, v56
    s_and_saveexec_b64 s[56:57], vcc
    buffer_store_dwordx2 v[36:37], v53, s[32:35], s54 offen sc1
    s_mov_b64 exec, s[56:57]
L_ab_noml:
    v_mul_u32_u24 v54, 144, v59
    v_lshl_add_u32 v54, v60, 4, v54
    ds_read_b128 v[8:11], v54 offset:32768
    ds_read_b128 v[12:15], v54 offset:35072
    ds_read_b128 v[16:19], v54 offset:32832
    ds_read_b128 v[20:23], v54 offset:35136
    v_lshrrev_b32 v52, 2, v59
    v_and_b32 v53, 3, v59
    v_lshl_add_u32 v52, v60, 3, v52
    v_mul_u32_u24 v52, 1040, v52
    v_lshl_add_u32 v52, v53, 3, v52
    s_lshl_b32 s54, s3, 8
    v_add_u32 v52, s54, v52
    v_add_u32 v52, 38400, v52
    ds_read_b64_tr_b16 v[24:25], v52 offset:0
    ds_read_b64_tr_b16 v[26:27], v52 offset:4160
    s_waitcnt lgkmcnt(0)
    v_mfma_f32_16x16x32_bf16 v[64:67], v[24:27], v[8:11], 0
    v_mfma_f32_16x16x32_bf16 v[96:99], v[24:27], v[12:15], 0
    ds_read_b64_tr_b16 v[28:29], v52 offset:33280
    ds_read_b64_tr_b16 v[30:31], v52 offset:37440
    s_waitcnt lgkmcnt(0)
    v_mfma_f32_16x16x32_bf16 v[64:67], v[28:31], v[16:19], v[64:67]
    v_mfma_f32_16x16x32_bf16 v[96:99], v[28:31], v[20:23], v[96:99]
    ds_read_b64_tr_b16 v[24:25], v52 offset:32
    ds_read_b64_tr_b16 v[26:27], v52 offset:4192
    s_waitcnt lgkmcnt(0)
    v_mfma_f32_16x16x32_bf16 v[68:71], v[24:27], v[8:11], 0
    v_mfma_f32_16x16x32_bf16 v[100:103], v[24:27], v[12:15], 0
    ds_read_b64_tr_b16 v[28:29], v52 offset:33312
    ds_read_b64_tr_b16 v[30:31], v52 offset:37472
    s_waitcnt lgkmcnt(0)
    v_mfma_f32_16x16x32_bf16 v[68:71], v[28:31], v[16:19], v[68:71]
    v_mfma_f32_16x16x32_bf16 v[100:103], v[28:31], v[20:23], v[100:103]
    ds_read_b64_tr_b16 v[24:25], v52 offset:64
    ds_read_b64_tr_b16 v[26:27], v52 offset:4224
    s_waitcnt lgkmcnt(0)
    v_mfma_f32_16x16x32_bf16 v[72:75], v[24:27], v[8:11], 0
    v_mfma_f32_16x16x32_bf16 v[104:107], v[24:27], v[12:15], 0
    ds_read_b64_tr_b16 v[28:29], v52 offset:33344
    ds_read_b64_tr_b16 v[30:31], v52 offset:37504
    s_waitcnt lgkmcnt(0)
    v_mfma_f32_16x16x32_bf16 v[72:75], v[28:31], v[16:19], v[72:75]
    v_mfma_f32_16x16x32_bf16 v[104:107], v[28:31], v[20:23], v[104:107]
    ds_read_b64_tr_b16 v[24:25], v52 offset:96
    ds_read_b64_tr_b16 v[26:27], v52 offset:4256
    s_waitcnt lgkmcnt(0)
    v_mfma_f32_16x16x32_bf16 v[76:79], v[24:27], v[8:11], 0
    v_mfma_f32_16x16x32_bf16 v[108:111], v[24:27], v[12:15], 0
    ds_read_b64_tr_b16 v[28:29], v52 offset:33376
    ds_read_b64_tr_b16 v[30:31], v52 offset:37536
    s_waitcnt lgkmcnt(0)
    v_mfma_f32_16x16x32_bf16 v[76:79], v[28:31], v[16:19], v[76:79]
    v_mfma_f32_16x16x32_bf16 v[108:111], v[28:31], v[20:23], v[108:111]
    ds_read_b64_tr_b16 v[24:25], v52 offset:128
    ds_read_b64_tr_b16 v[26:27], v52 offset:4288
    s_waitcnt lgkmcnt(0)
    v_mfma_f32_16x16x32_bf16 v[80:83], v[24:27], v[8:11], 0
    v_mfma_f32_16x16x32_bf16 v[112:115], v[24:27], v[12:15], 0
    ds_read_b64_tr_b16 v[28:29], v52 offset:33408
    ds_read_b64_tr_b16 v[30:31], v52 offset:37568
    s_waitcnt lgkmcnt(0)
    v_mfma_f32_16x16x32_bf16 v[80:83], v[28:31], v[16:19], v[80:83]
    v_mfma_f32_16x16x32_bf16 v[112:115], v[28:31], v[20:23], v[112:115]
    ds_read_b64_tr_b16 v[24:25], v52 offset:160
    ds_read_b64_tr_b16 v[26:27], v52 offset:4320
    s_waitcnt lgkmcnt(0)
    v_mfma_f32_16x16x32_bf16 v[84:87], v[24:27], v[8:11], 0
    v_mfma_f32_16x16x32_bf16 v[116:119], v[24:27], v[12:15], 0
    ds_read_b64_tr_b16 v[28:29], v52 offset:33440
    ds_read_b64_tr_b16 v[30:31], v52 offset:37600
    s_waitcnt lgkmcnt(0)
    v_mfma_f32_16x16x32_bf16 v[84:87], v[28:31], v[16:19], v[84:87]
    v_mfma_f32_16x16x32_bf16 v[116:119], v[28:31], v[20:23], v[116:119]
    ds_read_b64_tr_b16 v[24:25], v52 offset:192
    ds_read_b64_tr_b16 v[26:27], v52 offset:4352
    s_waitcnt lgkmcnt(0)
    v_mfma_f32_16x16x32_bf16 v[88:91], v[24:27], v[8:11], 0
    v_mfma_f32_16x16x32_bf16 v[120:123], v[24:27], v[12:15], 0
    ds_read_b64_tr_b16 v[28:29], v52 offset:33472
    ds_read_b64_tr_b16 v[30:31], v52 offset:37632
    s_waitcnt lgkmcnt(0)
    v_mfma_f32_16x16x32_bf16 v[88:91], v[28:31], v[16:19], v[88:91]
    v_mfma_f32_16x16x32_bf16 v[120:123], v[28:31], v[20:23], v[120:123]
    ds_read_b64_tr_b16 v[24:25], v52 offset:224
    ds_read_b64_tr_b16 v[26:27], v52 offset:4384
    s_waitcnt lgkmcnt(0)
    v_mfma_f32_16x16x32_bf16 v[92:95], v[24:27], v[8:11], 0
    v_mfma_f32_16x16x32_bf16 v[124:127], v[24:27], v[12:15], 0
    ds_read_b64_tr_b16 v[28:29], v52 offset:33504
    ds_read_b64_tr_b16 v[30:31], v52 offset:37664
    s_waitcnt lgkmcnt(0)
    v_mfma_f32_16x16x32_bf16 v[92:95], v[28:31], v[16:19], v[92:95]
    v_mfma_f32_16x16x32_bf16 v[124:127], v[28:31], v[20:23], v[124:127]
    s_nop 7
    s_nop 1
    s_lshl_b32 s54, s2, 16
    s_lshl_b32 s55, s3, 9
    s_add_u32 s54, s54, s55
    s_add_u32 s54, s54, 524288
    v_lshlrev_b32 v52, 11, v59
    v_lshl_add_u32 v52, v60, 4, v52
    s_add_u32 s55, s54, 0
    buffer_store_dwordx4 v[64:67], v52, s[32:35], s55 offen offset:0 sc1
    buffer_store_dwordx4 v[68:71], v52, s[32:35], s55 offen offset:64 sc1
    buffer_store_dwordx4 v[72:75], v52, s[32:35], s55 offen offset:128 sc1
    buffer_store_dwordx4 v[76:79], v52, s[32:35], s55 offen offset:192 sc1
    buffer_store_dwordx4 v[80:83], v52, s[32:35], s55 offen offset:256 sc1
    buffer_store_dwordx4 v[84:87], v52, s[32:35], s55 offen offset:320 sc1
    buffer_store_dwordx4 v[88:91], v52, s[32:35], s55 offen offset:384 sc1
    buffer_store_dwordx4 v[92:95], v52, s[32:35], s55 offen offset:448 sc1
    s_add_u32 s55, s54, 32768
    buffer_store_dwordx4 v[96:99], v52, s[32:35], s55 offen offset:0 sc1
    buffer_store_dwordx4 v[100:103], v52, s[32:35], s55 offen offset:64 sc1
    buffer_store_dwordx4 v[104:107], v52, s[32:35], s55 offen offset:128 sc1
    buffer_store_dwordx4 v[108:111], v52, s[32:35], s55 offen offset:192 sc1
    buffer_store_dwordx4 v[112:115], v52, s[32:35], s55 offen offset:256 sc1
    buffer_store_dwordx4 v[116:119], v52, s[32:35], s55 offen offset:320 sc1
    buffer_store_dwordx4 v[120:123], v52, s[32:35], s55 offen offset:384 sc1
    buffer_store_dwordx4 v[124:127], v52, s[32:35], s55 offen offset:448 sc1
    s_waitcnt vmcnt(0)
    s_waitcnt lgkmcnt(0)
    v_mov_b32 v44, 60
    v_mov_b32 v45, 1
    s_mov_b64 exec, 1
    ds_add_u32 v44, v45
    s_mov_b64 exec, -1
SB_15:
    ds_read_b32 v45, v44
    s_waitcnt lgkmcnt(0)
    v_readfirstlane_b32 s90, v45
    s_cmp_ge_u32 s90, 4
    s_cbranch_scc1 SB_15d
    s_sleep 1
    s_branch SB_15
SB_15d:
    s_cmp_lg_u32 s3, 0
    s_cbranch_scc1 L_ab_s
    s_lshl_b32 s54, s2, 2
    s_add_u32 s54, s54, 12592128
    v_mov_b32 v44, s54
    v_mov_b32 v45, s89
    s_mov_b64 exec, 1
    buffer_store_dword v45, v44, s[32:35], 0 offen sc1
    s_mov_b64 exec, -1
L_ab_s:
    s_lshl_b32 s54, s3, 6
    v_add_u32 v0, s54, v56
    s_cmp_ge_u32 s2, 72
    s_cbranch_scc1 L_h_nopf
    s_mov_b32 s63, s2
    s_mov_b32 s84, s24
    s_mov_b32 s85, s25
    s_mov_b32 s86, 4718592
    s_mov_b32 s87, 0x00020000
    s_mul_i32 s65, s63, 7282
    s_lshr_b32 s65, s65, 16
    s_mul_i32 s64, s65, 9
    s_sub_u32 s64, s63, s64
    v_and_b32 v1, 7, v0
    v_lshrrev_b32 v2, 3, v0
    v_mul_u32_u24 v3, 1152, v2
    v_lshl_add_u32 v3, v1, 4, v3
    s_mul_i32 s55, s65, 589824
    s_lshl_b32 s54, s64, 7
    s_add_u32 s55, s55, s54
    s_add_u32 s54, s55, 0
    buffer_load_dwordx4 a[0:3], v3, s[84:87], s54 offen
    s_add_u32 s54, s55, 36864
    buffer_load_dwordx4 a[4:7], v3, s[84:87], s54 offen
    s_add_u32 s54, s55, 73728
    buffer_load_dwordx4 a[8:11], v3, s[84:87], s54 offen
    s_add_u32 s54, s55, 110592
    buffer_load_dwordx4 a[12:15], v3, s[84:87], s54 offen
    s_add_u32 s54, s55, 147456
    buffer_load_dwordx4 a[16:19], v3, s[84:87], s54 offen
    s_add_u32 s54, s55, 184320
    buffer_load_dwordx4 a[20:23], v3, s[84:87], s54 offen
    s_add_u32 s54, s55, 221184
    buffer_load_dwordx4 a[24:27], v3, s[84:87], s54 offen
    s_add_u32 s54, s55, 258048
    buffer_load_dwordx4 a[28:31], v3, s[84:87], s54 offen
    s_add_u32 s54, s55, 294912
    buffer_load_dwordx4 a[32:35], v3, s[84:87], s54 offen
    s_add_u32 s54, s55, 331776
    buffer_load_dwordx4 a[36:39], v3, s[84:87], s54 offen
    s_add_u32 s54, s55, 368640
    buffer_load_dwordx4 a[40:43], v3, s[84:87], s54 offen
    s_add_u32 s54, s55, 405504
    buffer_load_dwordx4 a[44:47], v3, s[84:87], s54 offen
    s_add_u32 s54, s55, 442368
    buffer_load_dwordx4 a[48:51], v3, s[84:87], s54 offen
    s_add_u32 s54, s55, 479232
    buffer_load_dwordx4 a[52:55], v3, s[84:87], s54 offen
    s_add_u32 s54, s55, 516096
    buffer_load_dwordx4 a[56:59], v3, s[84:87], s54 offen
    s_add_u32 s54, s55, 552960
    buffer_load_dwordx4 a[60:63], v3, s[84:87], s54 offen
L_h_nopf:
    s_mov_b32 s44, s22
    s_mov_b32 s45, s23
    s_mov_b32 s46, 4194304
    s_mov_b32 s47, 0x00020000
    v_and_b32 v1, 15, v0
    v_lshrrev_b32 v2, 4, v0
    v_lshlrev_b32 v3, 4, v1
    v_lshl_add_u32 v3, v2, 13, v3
    s_lshl_b32 s54, s61, 8
    s_lshl_b32 s55, s62, 20
    s_add_u32 s55, s55, s54
    s_add_u32 s54, s55, 0
    buffer_load_dwordx4 v[64:67], v3, s[44:47], s54 offen
    s_add_u32 s54, s55, 131072
    buffer_load_dwordx4 v[68:71], v3, s[44:47], s54 offen
    s_add_u32 s54, s55, 262144
    buffer_load_dwordx4 v[72:75], v3, s[44:47], s54 offen
    s_add_u32 s54, s55, 393216
    buffer_load_dwordx4 v[76:79], v3, s[44:47], s54 offen
    s_add_u32 s54, s55, 524288
    buffer_load_dwordx4 v[80:83], v3, s[44:47], s54 offen
    s_add_u32 s54, s55, 655360
    buffer_load_dwordx4 v[84:87], v3, s[44:47], s54 offen
    s_add_u32 s54, s55, 786432
    buffer_load_dwordx4 v[88:91], v3, s[44:47], s54 offen
    s_add_u32 s54, s55, 917504
    buffer_load_dwordx4 v[92:95], v3, s[44:47], s54 offen
    s_cmp_lg_u32 s3, 0
    s_cbranch_scc1 L_bc_w
    s_mov_b32 s54, 12592128
    v_lshlrev_b32 v61, 2, v56
GP_16:
    buffer_load_dword v62, v61, s[32:35], s54 offen sc1
    buffer_load_dword v63, v61, s[32:35], s54 offen offset:256 sc1
    s_waitcnt vmcnt(0)
    v_cmp_ne_u32 vcc, s89, v62
    v_cmp_ne_u32 s[96:97], s89, v63
    s_or_b64 vcc, vcc, s[96:97]
    s_cmp_eq_u64 vcc, 0
    s_cbranch_scc1 GP_16d
    s_sleep 16
    s_branch GP_16
GP_16d:
    s_waitcnt lgkmcnt(0)
    v_mov_b32 v61, 12
    v_mov_b32 v62, 1
    s_mov_b64 exec, 1
    ds_add_u32 v61, v62
    s_mov_b64 exec, -1
L_bc_w:
    v_mov_b32 v61, 12
LW_17:
    ds_read_b32 v62, v61
    s_waitcnt lgkmcnt(0)
    v_readfirstlane_b32 s90, v62
    s_cmp_ge_u32 s90, 1
    s_cbranch_scc1 LW_17d
    s_sleep 1
    s_branch LW_17
LW_17d:
    v_lshlrev_b32 v4, 8, v0
    s_lshl_b32 s54, s61, 3
    s_add_u32 s54, s54, 8912896
    s_cmp_ge_u32 s3, 2
    s_cbranch_scc1 L_bc_p0
    buffer_load_dwordx2 v[6:7], v4, s[32:35], s54 offen sc1
    s_waitcnt vmcnt(0)
    v_mov_b32 v8, v6
    v_xor_b32 v10, 1, v56
    v_lshlrev_b32 v10, 2, v10
    ds_bpermute_b32 v9, v10, v8
    s_waitcnt lgkmcnt(0)
    v_max_f32 v8, v8, v9
    v_xor_b32 v10, 2, v56
    v_lshlrev_b32 v10, 2, v10
    ds_bpermute_b32 v9, v10, v8
    s_waitcnt lgkmcnt(0)
    v_max_f32 v8, v8, v9
    v_xor_b32 v10, 4, v56
    v_lshlrev_b32 v10, 2, v10
    ds_bpermute_b32 v9, v10, v8
    s_waitcnt lgkmcnt(0)
    v_max_f32 v8, v8, v9
    v_xor_b32 v10, 8, v56
    v_lshlrev_b32 v10, 2, v10
    ds_bpermute_b32 v9, v10, v8
    s_waitcnt lgkmcnt(0)
    v_max_f32 v8, v8, v9
    v_xor_b32 v10, 16, v56
    v_lshlrev_b32 v10, 2, v10
    ds_bpermute_b32 v9, v10, v8
    s_waitcnt lgkmcnt(0)
    v_max_f32 v8, v8, v9
    v_xor_b32 v10, 32, v56
    v_lshlrev_b32 v10, 2, v10
    ds_bpermute_b32 v9, v10, v8
    s_waitcnt lgkmcnt(0)
    v_max_f32 v8, v8, v9
    v_sub_f32 v6, v6, v8
    v_exp_f32 v6, v6
    s_nop 0
    v_mul_f32 v8, v6, v7
    v_xor_b32 v10, 1, v56
    v_lshlrev_b32 v10, 2, v10
    ds_bpermute_b32 v9, v10, v8
    s_waitcnt lgkmcnt(0)
    v_add_f32 v8, v8, v9
    v_xor_b32 v10, 2, v56
    v_lshlrev_b32 v10, 2, v10
    ds_bpermute_b32 v9, v10, v8
    s_waitcnt lgkmcnt(0)
    v_add_f32 v8, v8, v9
    v_xor_b32 v10, 4, v56
    v_lshlrev_b32 v10, 2, v10
    ds_bpermute_b32 v9, v10, v8
    s_waitcnt lgkmcnt(0)
    v_add_f32 v8, v8, v9
    v_xor_b32 v10, 8, v56
    v_lshlrev_b32 v10, 2, v10
    ds_bpermute_b32 v9, v10, v8
    s_waitcnt lgkmcnt(0)
    v_add_f32 v8, v8, v9
    v_xor_b32 v10, 16, v56
    v_lshlrev_b32 v10, 2, v10
    ds_bpermute_b32 v9, v10, v8
    s_waitcnt lgkmcnt(0)
    v_add_f32 v8, v8, v9
    v_xor_b32 v10, 32, v56
    v_lshlrev_b32 v10, 2, v10
    ds_bpermute_b32 v9, v10, v8
    s_waitcnt lgkmcnt(0)
    v_add_f32 v8, v8, v9
    v_rcp_f32 v8, v8
    s_nop 0
    v_mul_f32 v6, v6, v8
    v_lshlrev_b32 v4, 2, v0
    ds_write_b32 v4, v6 offset:8192
L_bc_p0:
    v_and_b32 v4, 31, v0
    v_lshrrev_b32 v5, 5, v0
    v_lshlrev_b32 v6, 19, v5
    v_lshl_add_u32 v6, v4, 4, v6
    s_lshl_b32 s54, s61, 11
    s_lshl_b32 s55, s62, 9
    s_add_u32 s54, s54, s55
    s_add_u32 s54, s54, 524288
    s_add_u32 s55, s54, 0
    buffer_load_dwordx4 v[96:99], v6, s[32:35], s55 offen sc1
    s_add_u32 s55, s54, 65536
    buffer_load_dwordx4 v[100:103], v6, s[32:35], s55 offen sc1
    s_add_u32 s55, s54, 131072
    buffer_load_dwordx4 v[104:107], v6, s[32:35], s55 offen sc1
    s_add_u32 s55, s54, 196608
    buffer_load_dwordx4 v[108:111], v6, s[32:35], s55 offen sc1
    s_add_u32 s55, s54, 262144
    buffer_load_dwordx4 v[112:115], v6, s[32:35], s55 offen sc1
    s_add_u32 s55, s54, 327680
    buffer_load_dwordx4 v[116:119], v6, s[32:35], s55 offen sc1
    s_add_u32 s55, s54, 393216
    buffer_load_dwordx4 v[120:123], v6, s[32:35], s55 offen sc1
    s_add_u32 s55, s54, 458752
    buffer_load_dwordx4 v[124:127], v6, s[32:35], s55 offen sc1
    s_add_u32 s55, s54, 4194304
    buffer_load_dwordx4 v[16:19], v6, s[32:35], s55 offen sc1
    s_add_u32 s55, s54, 4259840
    buffer_load_dwordx4 v[20:23], v6, s[32:35], s55 offen sc1
    s_add_u32 s55, s54, 4325376
    buffer_load_dwordx4 v[24:27], v6, s[32:35], s55 offen sc1
    s_add_u32 s55, s54, 4390912
    buffer_load_dwordx4 v[28:31], v6, s[32:35], s55 offen sc1
    s_add_u32 s55, s54, 4456448
    buffer_load_dwordx4 v[32:35], v6, s[32:35], s55 offen sc1
    s_add_u32 s55, s54, 4521984
    buffer_load_dwordx4 v[36:39], v6, s[32:35], s55 offen sc1
    s_add_u32 s55, s54, 4587520
    buffer_load_dwordx4 v[40:43], v6, s[32:35], s55 offen sc1
    s_add_u32 s55, s54, 4653056
    buffer_load_dwordx4 v[44:47], v6, s[32:35], s55 offen sc1
    s_waitcnt lgkmcnt(0)
    v_mov_b32 v61, 64
    v_mov_b32 v62, 1
    s_mov_b64 exec, 1
    ds_add_u32 v61, v62
    s_mov_b64 exec, -1
SB_18:
    ds_read_b32 v62, v61
    s_waitcnt lgkmcnt(0)
    v_readfirstlane_b32 s90, v62
    s_cmp_ge_u32 s90, 4
    s_cbranch_scc1 SB_18d
    s_sleep 1
    s_branch SB_18
SB_18d:
    v_lshlrev_b32 v7, 5, v5
    ds_read_b128 v[48:51], v7 offset:8192
    ds_read_b128 v[52:55], v7 offset:8208
    ds_read_b128 v[8:11], v7 offset:8448
    ds_read_b128 v[12:15], v7 offset:8464
    s_waitcnt vmcnt(0) lgkmcnt(0)
    v_mul_f32 v58, v96, v48
    v_mul_f32 v59, v97, v48
    v_mul_f32 v60, v98, v48
    v_mul_f32 v61, v99, v48
    v_fmac_f32 v58, v100, v49
    v_fmac_f32 v59, v101, v49
    v_fmac_f32 v60, v102, v49
    v_fmac_f32 v61, v103, v49
    v_fmac_f32 v58, v104, v50
    v_fmac_f32 v59, v105, v50
    v_fmac_f32 v60, v106, v50
    v_fmac_f32 v61, v107, v50
    v_fmac_f32 v58, v108, v51
    v_fmac_f32 v59, v109, v51
    v_fmac_f32 v60, v110, v51
    v_fmac_f32 v61, v111, v51
    v_fmac_f32 v58, v112, v52
    v_fmac_f32 v59, v113, v52
    v_fmac_f32 v60, v114, v52
    v_fmac_f32 v61, v115, v52
    v_fmac_f32 v58, v116, v53
    v_fmac_f32 v59, v117, v53
    v_fmac_f32 v60, v118, v53
    v_fmac_f32 v61, v119, v53
    v_fmac_f32 v58, v120, v54
    v_fmac_f32 v59, v121, v54
    v_fmac_f32 v60, v122, v54
    v_fmac_f32 v61, v123, v54
    v_fmac_f32 v58, v124, v55
    v_fmac_f32 v59, v125, v55
    v_fmac_f32 v60, v126, v55
    v_fmac_f32 v61, v127, v55
    v_mul_f32 v96, v16, v8
    v_mul_f32 v97, v17, v8
    v_mul_f32 v98, v18, v8
    v_mul_f32 v99, v19, v8
    v_fmac_f32 v96, v20, v9
    v_fmac_f32 v97, v21, v9
    v_fmac_f32 v98, v22, v9
    v_fmac_f32 v99, v23, v9
    v_fmac_f32 v96, v24, v10
    v_fmac_f32 v97, v25, v10
    v_fmac_f32 v98, v26, v10
    v_fmac_f32 v99, v27, v10
    v_fmac_f32 v96, v28, v11
    v_fmac_f32 v97, v29, v11
    v_fmac_f32 v98, v30, v11
    v_fmac_f32 v99, v31, v11
    v_fmac_f32 v96, v32, v12
    v_fmac_f32 v97, v33, v12
    v_fmac_f32 v98, v34, v12
    v_fmac_f32 v99, v35, v12
    v_fmac_f32 v96, v36, v13
    v_fmac_f32 v97, v37, v13
    v_fmac_f32 v98, v38, v13
    v_fmac_f32 v99, v39, v13
    v_fmac_f32 v96, v40, v14
    v_fmac_f32 v97, v41, v14
    v_fmac_f32 v98, v42, v14
    v_fmac_f32 v99, v43, v14
    v_fmac_f32 v96, v44, v15
    v_fmac_f32 v97, v45, v15
    v_fmac_f32 v98, v46, v15
    v_fmac_f32 v99, v47, v15
    v_lshlrev_b32 v7, 10, v5
    v_lshl_add_u32 v7, v4, 4, v7
    ds_write_b128 v7, v[58:61] offset:8704
    ds_write_b128 v7, v[96:99] offset:9216
    s_waitcnt lgkmcnt(0)
    v_mov_b32 v61, 68
    v_mov_b32 v62, 1
    s_mov_b64 exec, 1
    ds_add_u32 v61, v62
    s_mov_b64 exec, -1
SB_19:
    ds_read_b32 v62, v61
    s_waitcnt lgkmcnt(0)
    v_readfirstlane_b32 s90, v62
    s_cmp_ge_u32 s90, 4
    s_cbranch_scc1 SB_19d
    s_sleep 1
    s_branch SB_19
SB_19d:
    v_lshlrev_b32 v7, 2, v0
    ds_read_b32 v8, v7 offset:8704
    ds_read_b32 v9, v7 offset:9728
    ds_read_b32 v10, v7 offset:10752
    ds_read_b32 v11, v7 offset:11776
    ds_read_b32 v12, v7 offset:12800
    ds_read_b32 v13, v7 offset:13824
    ds_read_b32 v14, v7 offset:14848
    ds_read_b32 v15, v7 offset:15872
    s_waitcnt lgkmcnt(0)
    v_add_f32 v8, v8, v9
    v_add_f32 v8, v8, v10
    v_add_f32 v8, v8, v11
    v_add_f32 v8, v8, v12
    v_add_f32 v8, v8, v13
    v_add_f32 v8, v8, v14
    v_add_f32 v8, v8, v15
    ds_write_b32 v7, v8 offset:16896
    s_waitcnt lgkmcnt(0)
    v_mov_b32 v61, 72
    v_mov_b32 v62, 1
    s_mov_b64 exec, 1
    ds_add_u32 v61, v62
    s_mov_b64 exec, -1
SB_20:
    ds_read_b32 v62, v61
    s_waitcnt lgkmcnt(0)
    v_readfirstlane_b32 s90, v62
    s_cmp_ge_u32 s90, 4
    s_cbranch_scc1 SB_20d
    s_sleep 1
    s_branch SB_20
SB_20d:
    v_lshlrev_b32 v7, 2, v2
    ds_read_b32 v8, v7 offset:16896
    ds_read_b32 v16, v7 offset:17408
    ds_read_b32 v9, v7 offset:16960
    ds_read_b32 v17, v7 offset:17472
    ds_read_b32 v10, v7 offset:17024
    ds_read_b32 v18, v7 offset:17536
    ds_read_b32 v11, v7 offset:17088
    ds_read_b32 v19, v7 offset:17600
    ds_read_b32 v12, v7 offset:17152
    ds_read_b32 v20, v7 offset:17664
    ds_read_b32 v13, v7 offset:17216
    ds_read_b32 v21, v7 offset:17728
    ds_read_b32 v14, v7 offset:17280
    ds_read_b32 v22, v7 offset:17792
    ds_read_b32 v15, v7 offset:17344
    ds_read_b32 v23, v7 offset:17856
    v_mov_b32 v24, 0
    v_mov_b32 v25, 0
    v_mov_b32 v26, 0
    v_mov_b32 v27, 0
    v_mov_b32 v28, 0
    v_mov_b32 v29, 0
    v_mov_b32 v30, 0
    v_mov_b32 v31, 0
    v_mov_b32 v32, 0
    v_mov_b32 v33, 0
    v_mov_b32 v34, 0
    v_mov_b32 v35, 0
    v_mov_b32 v36, 0
    v_mov_b32 v37, 0
    v_mov_b32 v38, 0
    v_mov_b32 v39, 0
    s_waitcnt lgkmcnt(0)
    v_lshlrev_b32 v4, 16, v64
    v_and_b32 v5, 0xffff0000, v64
    v_fmac_f32 v24, v4, v8
    v_fmac_f32 v25, v5, v8
    v_fmac_f32 v32, v4, v16
    v_fmac_f32 v33, v5, v16
    v_lshlrev_b32 v4, 16, v65
    v_and_b32 v5, 0xffff0000, v65
    v_fmac_f32 v26, v4, v8
    v_fmac_f32 v27, v5, v8
    v_fmac_f32 v34, v4, v16
    v_fmac_f32 v35, v5, v16
    v_lshlrev_b32 v4, 16, v66
    v_and_b32 v5, 0xffff0000, v66
    v_fmac_f32 v28, v4, v8
    v_fmac_f32 v29, v5, v8
    v_fmac_f32 v36, v4, v16
    v_fmac_f32 v37, v5, v16
    v_lshlrev_b32 v4, 16, v67
    v_and_b32 v5, 0xffff0000, v67
    v_fmac_f32 v30, v4, v8
    v_fmac_f32 v31, v5, v8
    v_fmac_f32 v38, v4, v16
    v_fmac_f32 v39, v5, v16
    v_lshlrev_b32 v4, 16, v68
    v_and_b32 v5, 0xffff0000, v68
    v_fmac_f32 v24, v4, v9
    v_fmac_f32 v25, v5, v9
    v_fmac_f32 v32, v4, v17
    v_fmac_f32 v33, v5, v17
    v_lshlrev_b32 v4, 16, v69
    v_and_b32 v5, 0xffff0000, v69
    v_fmac_f32 v26, v4, v9
    v_fmac_f32 v27, v5, v9
    v_fmac_f32 v34, v4, v17
    v_fmac_f32 v35, v5, v17
    v_lshlrev_b32 v4, 16, v70
    v_and_b32 v5, 0xffff0000, v70
    v_fmac_f32 v28, v4, v9
    v_fmac_f32 v29, v5, v9
    v_fmac_f32 v36, v4, v17
    v_fmac_f32 v37, v5, v17
    v_lshlrev_b32 v4, 16, v71
    v_and_b32 v5, 0xffff0000, v71
    v_fmac_f32 v30, v4, v9
    v_fmac_f32 v31, v5, v9
    v_fmac_f32 v38, v4, v17
    v_fmac_f32 v39, v5, v17
    v_lshlrev_b32 v4, 16, v72
    v_and_b32 v5, 0xffff0000, v72
    v_fmac_f32 v24, v4, v10
    v_fmac_f32 v25, v5, v10
    v_fmac_f32 v32, v4, v18
    v_fmac_f32 v33, v5, v18
    v_lshlrev_b32 v4, 16, v73
    v_and_b32 v5, 0xffff0000, v73
    v_fmac_f32 v26, v4, v10
    v_fmac_f32 v27, v5, v10
    v_fmac_f32 v34, v4, v18
    v_fmac_f32 v35, v5, v18
    v_lshlrev_b32 v4, 16, v74
    v_and_b32 v5, 0xffff0000, v74
    v_fmac_f32 v28, v4, v10
    v_fmac_f32 v29, v5, v10
    v_fmac_f32 v36, v4, v18
    v_fmac_f32 v37, v5, v18
    v_lshlrev_b32 v4, 16, v75
    v_and_b32 v5, 0xffff0000, v75
    v_fmac_f32 v30, v4, v10
    v_fmac_f32 v31, v5, v10
    v_fmac_f32 v38, v4, v18
    v_fmac_f32 v39, v5, v18
    v_lshlrev_b32 v4, 16, v76
    v_and_b32 v5, 0xffff0000, v76
    v_fmac_f32 v24, v4, v11
    v_fmac_f32 v25, v5, v11
    v_fmac_f32 v32, v4, v19
    v_fmac_f32 v33, v5, v19
    v_lshlrev_b32 v4, 16, v77
    v_and_b32 v5, 0xffff0000, v77
    v_fmac_f32 v26, v4, v11
    v_fmac_f32 v27, v5, v11
    v_fmac_f32 v34, v4, v19
    v_fmac_f32 v35, v5, v19
    v_lshlrev_b32 v4, 16, v78
    v_and_b32 v5, 0xffff0000, v78
    v_fmac_f32 v28, v4, v11
    v_fmac_f32 v29, v5, v11
    v_fmac_f32 v36, v4, v19
    v_fmac_f32 v37, v5, v19
    v_lshlrev_b32 v4, 16, v79
    v_and_b32 v5, 0xffff0000, v79
    v_fmac_f32 v30, v4, v11
    v_fmac_f32 v31, v5, v11
    v_fmac_f32 v38, v4, v19
    v_fmac_f32 v39, v5, v19
    v_lshlrev_b32 v4, 16, v80
    v_and_b32 v5, 0xffff0000, v80
    v_fmac_f32 v24, v4, v12
    v_fmac_f32 v25, v5, v12
    v_fmac_f32 v32, v4, v20
    v_fmac_f32 v33, v5, v20
    v_lshlrev_b32 v4, 16, v81
    v_and_b32 v5, 0xffff0000, v81
    v_fmac_f32 v26, v4, v12
    v_fmac_f32 v27, v5, v12
    v_fmac_f32 v34, v4, v20
    v_fmac_f32 v35, v5, v20
    v_lshlrev_b32 v4, 16, v82
    v_and_b32 v5, 0xffff0000, v82
    v_fmac_f32 v28, v4, v12
    v_fmac_f32 v29, v5, v12
    v_fmac_f32 v36, v4, v20
    v_fmac_f32 v37, v5, v20
    v_lshlrev_b32 v4, 16, v83
    v_and_b32 v5, 0xffff0000, v83
    v_fmac_f32 v30, v4, v12
    v_fmac_f32 v31, v5, v12
    v_fmac_f32 v38, v4, v20
    v_fmac_f32 v39, v5, v20
    v_lshlrev_b32 v4, 16, v84
    v_and_b32 v5, 0xffff0000, v84
    v_fmac_f32 v24, v4, v13
    v_fmac_f32 v25, v5, v13
    v_fmac_f32 v32, v4, v21
    v_fmac_f32 v33, v5, v21
    v_lshlrev_b32 v4, 16, v85
    v_and_b32 v5, 0xffff0000, v85
    v_fmac_f32 v26, v4, v13
    v_fmac_f32 v27, v5, v13
    v_fmac_f32 v34, v4, v21
    v_fmac_f32 v35, v5, v21
    v_lshlrev_b32 v4, 16, v86
    v_and_b32 v5, 0xffff0000, v86
    v_fmac_f32 v28, v4, v13
    v_fmac_f32 v29, v5, v13
    v_fmac_f32 v36, v4, v21
    v_fmac_f32 v37, v5, v21
    v_lshlrev_b32 v4, 16, v87
    v_and_b32 v5, 0xffff0000, v87
    v_fmac_f32 v30, v4, v13
    v_fmac_f32 v31, v5, v13
    v_fmac_f32 v38, v4, v21
    v_fmac_f32 v39, v5, v21
    v_lshlrev_b32 v4, 16, v88
    v_and_b32 v5, 0xffff0000, v88
    v_fmac_f32 v24, v4, v14
    v_fmac_f32 v25, v5, v14
    v_fmac_f32 v32, v4, v22
    v_fmac_f32 v33, v5, v22
    v_lshlrev_b32 v4, 16, v89
    v_and_b32 v5, 0xffff0000, v89
    v_fmac_f32 v26, v4, v14
    v_fmac_f32 v27, v5, v14
    v_fmac_f32 v34, v4, v22
    v_fmac_f32 v35, v5, v22
    v_lshlrev_b32 v4, 16, v90
    v_and_b32 v5, 0xffff0000, v90
    v_fmac_f32 v28, v4, v14
    v_fmac_f32 v29, v5, v14
    v_fmac_f32 v36, v4, v22
    v_fmac_f32 v37, v5, v22
    v_lshlrev_b32 v4, 16, v91
    v_and_b32 v5, 0xffff0000, v91
    v_fmac_f32 v30, v4, v14
    v_fmac_f32 v31, v5, v14
    v_fmac_f32 v38, v4, v22
    v_fmac_f32 v39, v5, v22
    v_lshlrev_b32 v4, 16, v92
    v_and_b32 v5, 0xffff0000, v92
    v_fmac_f32 v24, v4, v15
    v_fmac_f32 v25, v5, v15
    v_fmac_f32 v32, v4, v23
    v_fmac_f32 v33, v5, v23
    v_lshlrev_b32 v4, 16, v93
    v_and_b32 v5, 0xffff0000, v93
    v_fmac_f32 v26, v4, v15
    v_fmac_f32 v27, v5, v15
    v_fmac_f32 v34, v4, v23
    v_fmac_f32 v35, v5, v23
    v_lshlrev_b32 v4, 16, v94
    v_and_b32 v5, 0xffff0000, v94
    v_fmac_f32 v28, v4, v15
    v_fmac_f32 v29, v5, v15
    v_fmac_f32 v36, v4, v23
    v_fmac_f32 v37, v5, v23
    v_lshlrev_b32 v4, 16, v95
    v_and_b32 v5, 0xffff0000, v95
    v_fmac_f32 v30, v4, v15
    v_fmac_f32 v31, v5, v15
    v_fmac_f32 v38, v4, v23
    v_fmac_f32 v39, v5, v23
    v_lshlrev_b32 v7, 10, v2
    v_lshl_add_u32 v7, v1, 5, v7
    ds_write_b128 v7, v[24:27] offset:17920
    ds_write_b128 v7, v[28:31] offset:17936
    ds_write_b128 v7, v[32:35] offset:18432
    ds_write_b128 v7, v[36:39] offset:18448
    s_waitcnt lgkmcnt(0)
    v_mov_b32 v61, 76
    v_mov_b32 v62, 1
    s_mov_b64 exec, 1
    ds_add_u32 v61, v62
    s_mov_b64 exec, -1
SB_21:
    ds_read_b32 v62, v61
    s_waitcnt lgkmcnt(0)
    v_readfirstlane_b32 s90, v62
    s_cmp_ge_u32 s90, 4
    s_cbranch_scc1 SB_21d
    s_sleep 1
    s_branch SB_21
SB_21d:
    v_lshlrev_b32 v7, 2, v0
    ds_read_b32 v8, v7 offset:17920
    ds_read_b32 v9, v7 offset:18944
    ds_read_b32 v10, v7 offset:19968
    ds_read_b32 v11, v7 offset:20992
    ds_read_b32 v12, v7 offset:22016
    ds_read_b32 v13, v7 offset:23040
    ds_read_b32 v14, v7 offset:24064
    ds_read_b32 v15, v7 offset:25088
    ds_read_b32 v16, v7 offset:26112
    ds_read_b32 v17, v7 offset:27136
    ds_read_b32 v18, v7 offset:28160
    ds_read_b32 v19, v7 offset:29184
    ds_read_b32 v20, v7 offset:30208
    ds_read_b32 v21, v7 offset:31232
    ds_read_b32 v22, v7 offset:32256
    ds_read_b32 v23, v7 offset:33280
    s_waitcnt lgkmcnt(0)
    v_add_f32 v8, v8, v9
    v_add_f32 v8, v8, v10
    v_add_f32 v8, v8, v11
    v_add_f32 v8, v8, v12
    v_add_f32 v8, v8, v13
    v_add_f32 v8, v8, v14
    v_add_f32 v8, v8, v15
    v_add_f32 v8, v8, v16
    v_add_f32 v8, v8, v17
    v_add_f32 v8, v8, v18
    v_add_f32 v8, v8, v19
    v_add_f32 v8, v8, v20
    v_add_f32 v8, v8, v21
    v_add_f32 v8, v8, v22
    v_add_f32 v8, v8, v23
    v_lshrrev_b32 v4, 7, v0
    v_and_b32 v5, 127, v0
    v_lshlrev_b32 v4, 14, v4
    v_lshl_add_u32 v4, v5, 2, v4
    s_lshl_b32 s54, s62, 15
    s_lshl_b32 s55, s61, 9
    s_add_u32 s54, s54, s55
    s_add_u32 s54, s54, 9437184
    buffer_store_dword v8, v4, s[32:35], s54 offen sc1
    s_waitcnt vmcnt(0)
    s_waitcnt lgkmcnt(0)
    v_mov_b32 v61, 80
    v_mov_b32 v62, 1
    s_mov_b64 exec, 1
    ds_add_u32 v61, v62
    s_mov_b64 exec, -1
SB_22:
    ds_read_b32 v62, v61
    s_waitcnt lgkmcnt(0)
    v_readfirstlane_b32 s90, v62
    s_cmp_ge_u32 s90, 4
    s_cbranch_scc1 SB_22d
    s_sleep 1
    s_branch SB_22
SB_22d:
    s_cmp_lg_u32 s3, 0
    s_cbranch_scc1 L_bc_s
    s_lshr_b32 s54, s53, 4
    s_lshl_b32 s54, s54, 7
    s_and_b32 s55, s53, 15
    s_lshl_b32 s55, s55, 2
    s_add_u32 s54, s54, s55
    s_add_u32 s54, s54, 12593152
    v_mov_b32 v61, s54
    v_mov_b32 v62, s89
    s_mov_b64 exec, 1
    buffer_store_dword v62, v61, s[32:35], 0 offen sc1
    s_mov_b64 exec, -1
L_bc_s:
    s_cmp_ge_u32 s2, 72
    s_cbranch_scc1 L_end
    s_mov_b32 s48, s26
    s_mov_b32 s49, s27
    s_mov_b32 s50, 4608
    s_mov_b32 s51, 0x00020000
    v_and_b32 v1, 7, v0
    v_lshrrev_b32 v2, 3, v0
    s_cmp_lg_u32 s3, 0
    s_cbranch_scc1 L_opB_w
    s_lshl_b32 s54, s65, 7
    s_add_u32 s54, s54, 12593152
    v_cmp_gt_u32 vcc, 16, v56
    v_lshlrev_b32 v61, 2, v56
    s_nop 1
    v_cndmask_b32 v61, 0, v61, vcc
GP_23:
    buffer_load_dword v62, v61, s[32:35], s54 offen sc1
    s_waitcnt vmcnt(0)
    v_cmp_ne_u32 vcc, s89, v62
    s_cmp_eq_u64 vcc, 0
    s_cbranch_scc1 GP_23d
    s_sleep 16
    s_branch GP_23
GP_23d:
    s_waitcnt lgkmcnt(0)
    v_mov_b32 v61, 16
    v_mov_b32 v62, 1
    s_mov_b64 exec, 1
    ds_add_u32 v61, v62
    s_mov_b64 exec, -1
L_opB_w:
    v_mov_b32 v61, 16
LW_24:
    ds_read_b32 v62, v61
    s_waitcnt lgkmcnt(0)
    v_readfirstlane_b32 s90, v62
    s_cmp_ge_u32 s90, 1
    s_cbranch_scc1 LW_24d
    s_sleep 1
    s_branch LW_24
LW_24d:
    v_lshrrev_b32 v4, 7, v0
    v_and_b32 v5, 127, v0
    s_lshl_b32 s54, s65, 2
    v_add_u32 v6, s54, v4
    v_lshlrev_b32 v6, 9, v6
    v_lshl_add_u32 v6, v5, 2, v6
    s_mov_b32 s55, 9437184
    buffer_load_dword v16, v6, s[32:35], s55 offen sc1
    s_mov_b32 s55, 9453568
    buffer_load_dword v17, v6, s[32:35], s55 offen sc1
    s_mov_b32 s55, 9469952
    buffer_load_dword v18, v6, s[32:35], s55 offen sc1
    s_mov_b32 s55, 9486336
    buffer_load_dword v19, v6, s[32:35], s55 offen sc1
    s_mov_b32 s55, 9502720
    buffer_load_dword v20, v6, s[32:35], s55 offen sc1
    s_mov_b32 s55, 9519104
    buffer_load_dword v21, v6, s[32:35], s55 offen sc1
    s_mov_b32 s55, 9535488
    buffer_load_dword v22, v6, s[32:35], s55 offen sc1
    s_mov_b32 s55, 9551872
    buffer_load_dword v23, v6, s[32:35], s55 offen sc1
    s_mov_b32 s55, 9438208
    buffer_load_dword v24, v6, s[32:35], s55 offen sc1
    s_mov_b32 s55, 9454592
    buffer_load_dword v25, v6, s[32:35], s55 offen sc1
    s_mov_b32 s55, 9470976
    buffer_load_dword v26, v6, s[32:35], s55 offen sc1
    s_mov_b32 s55, 9487360
    buffer_load_dword v27, v6, s[32:35], s55 offen sc1
    s_mov_b32 s55, 9503744
    buffer_load_dword v28, v6, s[32:35], s55 offen sc1
    s_mov_b32 s55, 9520128
    buffer_load_dword v29, v6, s[32:35], s55 offen sc1
    s_mov_b32 s55, 9536512
    buffer_load_dword v30, v6, s[32:35], s55 offen sc1
    s_mov_b32 s55, 9552896
    buffer_load_dword v31, v6, s[32:35], s55 offen sc1
    s_waitcnt vmcnt(0)
    v_add_f32 v8, v16, v18
    v_add_f32 v9, v17, v19
    v_add_f32 v8, v8, v20
    v_add_f32 v9, v9, v21
    v_add_f32 v8, v8, v22
    v_add_f32 v9, v9, v23
    v_add_f32 v10, v24, v26
    v_add_f32 v11, v25, v27
    v_add_f32 v10, v10, v28
    v_add_f32 v11, v11, v29
    v_add_f32 v10, v10, v30
    v_add_f32 v11, v11, v31
    v_lshlrev_b32 v6, 2, v0
    ds_write_b32 v6, v8 offset:8192
    ds_write_b32 v6, v9 offset:10240
    ds_write_b32 v6, v10 offset:9216
    ds_write_b32 v6, v11 offset:11264
    s_waitcnt lgkmcnt(0)
    v_mov_b32 v61, 84
    v_mov_b32 v62, 1
    s_mov_b64 exec, 1
    ds_add_u32 v61, v62
    s_mov_b64 exec, -1
SB_25:
    ds_read_b32 v62, v61
    s_waitcnt lgkmcnt(0)
    v_readfirstlane_b32 s90, v62
    s_cmp_ge_u32 s90, 4
    s_cbranch_scc1 SB_25d
    s_sleep 1
    s_branch SB_25
SB_25d:
    v_lshlrev_b32 v7, 2, v2
    v_mov_b32 v40, 0
    v_mov_b32 v41, 0
    v_mov_b32 v42, 0
    v_mov_b32 v43, 0
    v_mov_b32 v44, 0
    v_mov_b32 v45, 0
    v_mov_b32 v46, 0
    v_mov_b32 v47, 0
    v_mov_b32 v48, 0
    v_mov_b32 v49, 0
    v_mov_b32 v50, 0
    v_mov_b32 v51, 0
    v_mov_b32 v52, 0
    v_mov_b32 v53, 0
    v_mov_b32 v54, 0
    v_mov_b32 v55, 0
    ds_read_b32 v8, v7 offset:8192
    ds_read_b32 v24, v7 offset:10240
    ds_read_b32 v9, v7 offset:8320
    ds_read_b32 v25, v7 offset:10368
    ds_read_b32 v10, v7 offset:8448
    ds_read_b32 v26, v7 offset:10496
    ds_read_b32 v11, v7 offset:8576
    ds_read_b32 v27, v7 offset:10624
    ds_read_b32 v12, v7 offset:8704
    ds_read_b32 v28, v7 offset:10752
    ds_read_b32 v13, v7 offset:8832
    ds_read_b32 v29, v7 offset:10880
    ds_read_b32 v14, v7 offset:8960
    ds_read_b32 v30, v7 offset:11008
    ds_read_b32 v15, v7 offset:9088
    ds_read_b32 v31, v7 offset:11136
    ds_read_b32 v16, v7 offset:9216
    ds_read_b32 v32, v7 offset:11264
    ds_read_b32 v17, v7 offset:9344
    ds_read_b32 v33, v7 offset:11392
    ds_read_b32 v18, v7 offset:9472
    ds_read_b32 v34, v7 offset:11520
    ds_read_b32 v19, v7 offset:9600
    ds_read_b32 v35, v7 offset:11648
    ds_read_b32 v20, v7 offset:9728
    ds_read_b32 v36, v7 offset:11776
    ds_read_b32 v21, v7 offset:9856
    ds_read_b32 v37, v7 offset:11904
    ds_read_b32 v22, v7 offset:9984
    ds_read_b32 v38, v7 offset:12032
    ds_read_b32 v23, v7 offset:10112
    ds_read_b32 v39, v7 offset:12160
    s_waitcnt vmcnt(0) lgkmcnt(0)
    v_accvgpr_read_b32 v60, a0
    v_lshlrev_b32 v4, 16, v60
    v_and_b32 v5, 0xffff0000, v60
    v_fmac_f32 v40, v4, v8
    v_fmac_f32 v41, v5, v8
    v_fmac_f32 v48, v4, v24
    v_fmac_f32 v49, v5, v24
    v_accvgpr_read_b32 v60, a1
    v_lshlrev_b32 v4, 16, v60
    v_and_b32 v5, 0xffff0000, v60
    v_fmac_f32 v42, v4, v8
    v_fmac_f32 v43, v5, v8
    v_fmac_f32 v50, v4, v24
    v_fmac_f32 v51, v5, v24
    v_accvgpr_read_b32 v60, a2
    v_lshlrev_b32 v4, 16, v60
    v_and_b32 v5, 0xffff0000, v60
    v_fmac_f32 v44, v4, v8
    v_fmac_f32 v45, v5, v8
    v_fmac_f32 v52, v4, v24
    v_fmac_f32 v53, v5, v24
    v_accvgpr_read_b32 v60, a3
    v_lshlrev_b32 v4, 16, v60
    v_and_b32 v5, 0xffff0000, v60
    v_fmac_f32 v46, v4, v8
    v_fmac_f32 v47, v5, v8
    v_fmac_f32 v54, v4, v24
    v_fmac_f32 v55, v5, v24
    v_accvgpr_read_b32 v60, a4
    v_lshlrev_b32 v4, 16, v60
    v_and_b32 v5, 0xffff0000, v60
    v_fmac_f32 v40, v4, v9
    v_fmac_f32 v41, v5, v9
    v_fmac_f32 v48, v4, v25
    v_fmac_f32 v49, v5, v25
    v_accvgpr_read_b32 v60, a5
    v_lshlrev_b32 v4, 16, v60
    v_and_b32 v5, 0xffff0000, v60
    v_fmac_f32 v42, v4, v9
    v_fmac_f32 v43, v5, v9
    v_fmac_f32 v50, v4, v25
    v_fmac_f32 v51, v5, v25
    v_accvgpr_read_b32 v60, a6
    v_lshlrev_b32 v4, 16, v60
    v_and_b32 v5, 0xffff0000, v60
    v_fmac_f32 v44, v4, v9
    v_fmac_f32 v45, v5, v9
    v_fmac_f32 v52, v4, v25
    v_fmac_f32 v53, v5, v25
    v_accvgpr_read_b32 v60, a7
    v_lshlrev_b32 v4, 16, v60
    v_and_b32 v5, 0xffff0000, v60
    v_fmac_f32 v46, v4, v9
    v_fmac_f32 v47, v5, v9
    v_fmac_f32 v54, v4, v25
    v_fmac_f32 v55, v5, v25
    v_accvgpr_read_b32 v60, a8
    v_lshlrev_b32 v4, 16, v60
    v_and_b32 v5, 0xffff0000, v60
    v_fmac_f32 v40, v4, v10
    v_fmac_f32 v41, v5, v10
    v_fmac_f32 v48, v4, v26
    v_fmac_f32 v49, v5, v26
    v_accvgpr_read_b32 v60, a9
    v_lshlrev_b32 v4, 16, v60
    v_and_b32 v5, 0xffff0000, v60
    v_fmac_f32 v42, v4, v10
    v_fmac_f32 v43, v5, v10
    v_fmac_f32 v50, v4, v26
    v_fmac_f32 v51, v5, v26
    v_accvgpr_read_b32 v60, a10
    v_lshlrev_b32 v4, 16, v60
    v_and_b32 v5, 0xffff0000, v60
    v_fmac_f32 v44, v4, v10
    v_fmac_f32 v45, v5, v10
    v_fmac_f32 v52, v4, v26
    v_fmac_f32 v53, v5, v26
    v_accvgpr_read_b32 v60, a11
    v_lshlrev_b32 v4, 16, v60
    v_and_b32 v5, 0xffff0000, v60
    v_fmac_f32 v46, v4, v10
    v_fmac_f32 v47, v5, v10
    v_fmac_f32 v54, v4, v26
    v_fmac_f32 v55, v5, v26
    v_accvgpr_read_b32 v60, a12
    v_lshlrev_b32 v4, 16, v60
    v_and_b32 v5, 0xffff0000, v60
    v_fmac_f32 v40, v4, v11
    v_fmac_f32 v41, v5, v11
    v_fmac_f32 v48, v4, v27
    v_fmac_f32 v49, v5, v27
    v_accvgpr_read_b32 v60, a13
    v_lshlrev_b32 v4, 16, v60
    v_and_b32 v5, 0xffff0000, v60
    v_fmac_f32 v42, v4, v11
    v_fmac_f32 v43, v5, v11
    v_fmac_f32 v50, v4, v27
    v_fmac_f32 v51, v5, v27
    v_accvgpr_read_b32 v60, a14
    v_lshlrev_b32 v4, 16, v60
    v_and_b32 v5, 0xffff0000, v60
    v_fmac_f32 v44, v4, v11
    v_fmac_f32 v45, v5, v11
    v_fmac_f32 v52, v4, v27
    v_fmac_f32 v53, v5, v27
    v_accvgpr_read_b32 v60, a15
    v_lshlrev_b32 v4, 16, v60
    v_and_b32 v5, 0xffff0000, v60
    v_fmac_f32 v46, v4, v11
    v_fmac_f32 v47, v5, v11
    v_fmac_f32 v54, v4, v27
    v_fmac_f32 v55, v5, v27
    v_accvgpr_read_b32 v60, a16
    v_lshlrev_b32 v4, 16, v60
    v_and_b32 v5, 0xffff0000, v60
    v_fmac_f32 v40, v4, v12
    v_fmac_f32 v41, v5, v12
    v_fmac_f32 v48, v4, v28
    v_fmac_f32 v49, v5, v28
    v_accvgpr_read_b32 v60, a17
    v_lshlrev_b32 v4, 16, v60
    v_and_b32 v5, 0xffff0000, v60
    v_fmac_f32 v42, v4, v12
    v_fmac_f32 v43, v5, v12
    v_fmac_f32 v50, v4, v28
    v_fmac_f32 v51, v5, v28
    v_accvgpr_read_b32 v60, a18
    v_lshlrev_b32 v4, 16, v60
    v_and_b32 v5, 0xffff0000, v60
    v_fmac_f32 v44, v4, v12
    v_fmac_f32 v45, v5, v12
    v_fmac_f32 v52, v4, v28
    v_fmac_f32 v53, v5, v28
    v_accvgpr_read_b32 v60, a19
    v_lshlrev_b32 v4, 16, v60
    v_and_b32 v5, 0xffff0000, v60
    v_fmac_f32 v46, v4, v12
    v_fmac_f32 v47, v5, v12
    v_fmac_f32 v54, v4, v28
    v_fmac_f32 v55, v5, v28
    v_accvgpr_read_b32 v60, a20
    v_lshlrev_b32 v4, 16, v60
    v_and_b32 v5, 0xffff0000, v60
    v_fmac_f32 v40, v4, v13
    v_fmac_f32 v41, v5, v13
    v_fmac_f32 v48, v4, v29
    v_fmac_f32 v49, v5, v29
    v_accvgpr_read_b32 v60, a21
    v_lshlrev_b32 v4, 16, v60
    v_and_b32 v5, 0xffff0000, v60
    v_fmac_f32 v42, v4, v13
    v_fmac_f32 v43, v5, v13
    v_fmac_f32 v50, v4, v29
    v_fmac_f32 v51, v5, v29
    v_accvgpr_read_b32 v60, a22
    v_lshlrev_b32 v4, 16, v60
    v_and_b32 v5, 0xffff0000, v60
    v_fmac_f32 v44, v4, v13
    v_fmac_f32 v45, v5, v13
    v_fmac_f32 v52, v4, v29
    v_fmac_f32 v53, v5, v29
    v_accvgpr_read_b32 v60, a23
    v_lshlrev_b32 v4, 16, v60
    v_and_b32 v5, 0xffff0000, v60
    v_fmac_f32 v46, v4, v13
    v_fmac_f32 v47, v5, v13
    v_fmac_f32 v54, v4, v29
    v_fmac_f32 v55, v5, v29
    v_accvgpr_read_b32 v60, a24
    v_lshlrev_b32 v4, 16, v60
    v_and_b32 v5, 0xffff0000, v60
    v_fmac_f32 v40, v4, v14
    v_fmac_f32 v41, v5, v14
    v_fmac_f32 v48, v4, v30
    v_fmac_f32 v49, v5, v30
    v_accvgpr_read_b32 v60, a25
    v_lshlrev_b32 v4, 16, v60
    v_and_b32 v5, 0xffff0000, v60
    v_fmac_f32 v42, v4, v14
    v_fmac_f32 v43, v5, v14
    v_fmac_f32 v50, v4, v30
    v_fmac_f32 v51, v5, v30
    v_accvgpr_read_b32 v60, a26
    v_lshlrev_b32 v4, 16, v60
    v_and_b32 v5, 0xffff0000, v60
    v_fmac_f32 v44, v4, v14
    v_fmac_f32 v45, v5, v14
    v_fmac_f32 v52, v4, v30
    v_fmac_f32 v53, v5, v30
    v_accvgpr_read_b32 v60, a27
    v_lshlrev_b32 v4, 16, v60
    v_and_b32 v5, 0xffff0000, v60
    v_fmac_f32 v46, v4, v14
    v_fmac_f32 v47, v5, v14
    v_fmac_f32 v54, v4, v30
    v_fmac_f32 v55, v5, v30
    v_accvgpr_read_b32 v60, a28
    v_lshlrev_b32 v4, 16, v60
    v_and_b32 v5, 0xffff0000, v60
    v_fmac_f32 v40, v4, v15
    v_fmac_f32 v41, v5, v15
    v_fmac_f32 v48, v4, v31
    v_fmac_f32 v49, v5, v31
    v_accvgpr_read_b32 v60, a29
    v_lshlrev_b32 v4, 16, v60
    v_and_b32 v5, 0xffff0000, v60
    v_fmac_f32 v42, v4, v15
    v_fmac_f32 v43, v5, v15
    v_fmac_f32 v50, v4, v31
    v_fmac_f32 v51, v5, v31
    v_accvgpr_read_b32 v60, a30
    v_lshlrev_b32 v4, 16, v60
    v_and_b32 v5, 0xffff0000, v60
    v_fmac_f32 v44, v4, v15
    v_fmac_f32 v45, v5, v15
    v_fmac_f32 v52, v4, v31
    v_fmac_f32 v53, v5, v31
    v_accvgpr_read_b32 v60, a31
    v_lshlrev_b32 v4, 16, v60
    v_and_b32 v5, 0xffff0000, v60
    v_fmac_f32 v46, v4, v15
    v_fmac_f32 v47, v5, v15
    v_fmac_f32 v54, v4, v31
    v_fmac_f32 v55, v5, v31
    v_accvgpr_read_b32 v60, a32
    v_lshlrev_b32 v4, 16, v60
    v_and_b32 v5, 0xffff0000, v60
    v_fmac_f32 v40, v4, v16
    v_fmac_f32 v41, v5, v16
    v_fmac_f32 v48, v4, v32
    v_fmac_f32 v49, v5, v32
    v_accvgpr_read_b32 v60, a33
    v_lshlrev_b32 v4, 16, v60
    v_and_b32 v5, 0xffff0000, v60
    v_fmac_f32 v42, v4, v16
    v_fmac_f32 v43, v5, v16
    v_fmac_f32 v50, v4, v32
    v_fmac_f32 v51, v5, v32
    v_accvgpr_read_b32 v60, a34
    v_lshlrev_b32 v4, 16, v60
    v_and_b32 v5, 0xffff0000, v60
    v_fmac_f32 v44, v4, v16
    v_fmac_f32 v45, v5, v16
    v_fmac_f32 v52, v4, v32
    v_fmac_f32 v53, v5, v32
    v_accvgpr_read_b32 v60, a35
    v_lshlrev_b32 v4, 16, v60
    v_and_b32 v5, 0xffff0000, v60
    v_fmac_f32 v46, v4, v16
    v_fmac_f32 v47, v5, v16
    v_fmac_f32 v54, v4, v32
    v_fmac_f32 v55, v5, v32
    v_accvgpr_read_b32 v60, a36
    v_lshlrev_b32 v4, 16, v60
    v_and_b32 v5, 0xffff0000, v60
    v_fmac_f32 v40, v4, v17
    v_fmac_f32 v41, v5, v17
    v_fmac_f32 v48, v4, v33
    v_fmac_f32 v49, v5, v33
    v_accvgpr_read_b32 v60, a37
    v_lshlrev_b32 v4, 16, v60
    v_and_b32 v5, 0xffff0000, v60
    v_fmac_f32 v42, v4, v17
    v_fmac_f32 v43, v5, v17
    v_fmac_f32 v50, v4, v33
    v_fmac_f32 v51, v5, v33
    v_accvgpr_read_b32 v60, a38
    v_lshlrev_b32 v4, 16, v60
    v_and_b32 v5, 0xffff0000, v60
    v_fmac_f32 v44, v4, v17
    v_fmac_f32 v45, v5, v17
    v_fmac_f32 v52, v4, v33
    v_fmac_f32 v53, v5, v33
    v_accvgpr_read_b32 v60, a39
    v_lshlrev_b32 v4, 16, v60
    v_and_b32 v5, 0xffff0000, v60
    v_fmac_f32 v46, v4, v17
    v_fmac_f32 v47, v5, v17
    v_fmac_f32 v54, v4, v33
    v_fmac_f32 v55, v5, v33
    v_accvgpr_read_b32 v60, a40
    v_lshlrev_b32 v4, 16, v60
    v_and_b32 v5, 0xffff0000, v60
    v_fmac_f32 v40, v4, v18
    v_fmac_f32 v41, v5, v18
    v_fmac_f32 v48, v4, v34
    v_fmac_f32 v49, v5, v34
    v_accvgpr_read_b32 v60, a41
    v_lshlrev_b32 v4, 16, v60
    v_and_b32 v5, 0xffff0000, v60
    v_fmac_f32 v42, v4, v18
    v_fmac_f32 v43, v5, v18
    v_fmac_f32 v50, v4, v34
    v_fmac_f32 v51, v5, v34
    v_accvgpr_read_b32 v60, a42
    v_lshlrev_b32 v4, 16, v60
    v_and_b32 v5, 0xffff0000, v60
    v_fmac_f32 v44, v4, v18
    v_fmac_f32 v45, v5, v18
    v_fmac_f32 v52, v4, v34
    v_fmac_f32 v53, v5, v34
    v_accvgpr_read_b32 v60, a43
    v_lshlrev_b32 v4, 16, v60
    v_and_b32 v5, 0xffff0000, v60
    v_fmac_f32 v46, v4, v18
    v_fmac_f32 v47, v5, v18
    v_fmac_f32 v54, v4, v34
    v_fmac_f32 v55, v5, v34
    v_accvgpr_read_b32 v60, a44
    v_lshlrev_b32 v4, 16, v60
    v_and_b32 v5, 0xffff0000, v60
    v_fmac_f32 v40, v4, v19
    v_fmac_f32 v41, v5, v19
    v_fmac_f32 v48, v4, v35
    v_fmac_f32 v49, v5, v35
    v_accvgpr_read_b32 v60, a45
    v_lshlrev_b32 v4, 16, v60
    v_and_b32 v5, 0xffff0000, v60
    v_fmac_f32 v42, v4, v19
    v_fmac_f32 v43, v5, v19
    v_fmac_f32 v50, v4, v35
    v_fmac_f32 v51, v5, v35
    v_accvgpr_read_b32 v60, a46
    v_lshlrev_b32 v4, 16, v60
    v_and_b32 v5, 0xffff0000, v60
    v_fmac_f32 v44, v4, v19
    v_fmac_f32 v45, v5, v19
    v_fmac_f32 v52, v4, v35
    v_fmac_f32 v53, v5, v35
    v_accvgpr_read_b32 v60, a47
    v_lshlrev_b32 v4, 16, v60
    v_and_b32 v5, 0xffff0000, v60
    v_fmac_f32 v46, v4, v19
    v_fmac_f32 v47, v5, v19
    v_fmac_f32 v54, v4, v35
    v_fmac_f32 v55, v5, v35
    v_accvgpr_read_b32 v60, a48
    v_lshlrev_b32 v4, 16, v60
    v_and_b32 v5, 0xffff0000, v60
    v_fmac_f32 v40, v4, v20
    v_fmac_f32 v41, v5, v20
    v_fmac_f32 v48, v4, v36
    v_fmac_f32 v49, v5, v36
    v_accvgpr_read_b32 v60, a49
    v_lshlrev_b32 v4, 16, v60
    v_and_b32 v5, 0xffff0000, v60
    v_fmac_f32 v42, v4, v20
    v_fmac_f32 v43, v5, v20
    v_fmac_f32 v50, v4, v36
    v_fmac_f32 v51, v5, v36
    v_accvgpr_read_b32 v60, a50
    v_lshlrev_b32 v4, 16, v60
    v_and_b32 v5, 0xffff0000, v60
    v_fmac_f32 v44, v4, v20
    v_fmac_f32 v45, v5, v20
    v_fmac_f32 v52, v4, v36
    v_fmac_f32 v53, v5, v36
    v_accvgpr_read_b32 v60, a51
    v_lshlrev_b32 v4, 16, v60
    v_and_b32 v5, 0xffff0000, v60
    v_fmac_f32 v46, v4, v20
    v_fmac_f32 v47, v5, v20
    v_fmac_f32 v54, v4, v36
    v_fmac_f32 v55, v5, v36
    v_accvgpr_read_b32 v60, a52
    v_lshlrev_b32 v4, 16, v60
    v_and_b32 v5, 0xffff0000, v60
    v_fmac_f32 v40, v4, v21
    v_fmac_f32 v41, v5, v21
    v_fmac_f32 v48, v4, v37
    v_fmac_f32 v49, v5, v37
    v_accvgpr_read_b32 v60, a53
    v_lshlrev_b32 v4, 16, v60
    v_and_b32 v5, 0xffff0000, v60
    v_fmac_f32 v42, v4, v21
    v_fmac_f32 v43, v5, v21
    v_fmac_f32 v50, v4, v37
    v_fmac_f32 v51, v5, v37
    v_accvgpr_read_b32 v60, a54
    v_lshlrev_b32 v4, 16, v60
    v_and_b32 v5, 0xffff0000, v60
    v_fmac_f32 v44, v4, v21
    v_fmac_f32 v45, v5, v21
    v_fmac_f32 v52, v4, v37
    v_fmac_f32 v53, v5, v37
    v_accvgpr_read_b32 v60, a55
    v_lshlrev_b32 v4, 16, v60
    v_and_b32 v5, 0xffff0000, v60
    v_fmac_f32 v46, v4, v21
    v_fmac_f32 v47, v5, v21
    v_fmac_f32 v54, v4, v37
    v_fmac_f32 v55, v5, v37
    v_accvgpr_read_b32 v60, a56
    v_lshlrev_b32 v4, 16, v60
    v_and_b32 v5, 0xffff0000, v60
    v_fmac_f32 v40, v4, v22
    v_fmac_f32 v41, v5, v22
    v_fmac_f32 v48, v4, v38
    v_fmac_f32 v49, v5, v38
    v_accvgpr_read_b32 v60, a57
    v_lshlrev_b32 v4, 16, v60
    v_and_b32 v5, 0xffff0000, v60
    v_fmac_f32 v42, v4, v22
    v_fmac_f32 v43, v5, v22
    v_fmac_f32 v50, v4, v38
    v_fmac_f32 v51, v5, v38
    v_accvgpr_read_b32 v60, a58
    v_lshlrev_b32 v4, 16, v60
    v_and_b32 v5, 0xffff0000, v60
    v_fmac_f32 v44, v4, v22
    v_fmac_f32 v45, v5, v22
    v_fmac_f32 v52, v4, v38
    v_fmac_f32 v53, v5, v38
    v_accvgpr_read_b32 v60, a59
    v_lshlrev_b32 v4, 16, v60
    v_and_b32 v5, 0xffff0000, v60
    v_fmac_f32 v46, v4, v22
    v_fmac_f32 v47, v5, v22
    v_fmac_f32 v54, v4, v38
    v_fmac_f32 v55, v5, v38
    v_accvgpr_read_b32 v60, a60
    v_lshlrev_b32 v4, 16, v60
    v_and_b32 v5, 0xffff0000, v60
    v_fmac_f32 v40, v4, v23
    v_fmac_f32 v41, v5, v23
    v_fmac_f32 v48, v4, v39
    v_fmac_f32 v49, v5, v39
    v_accvgpr_read_b32 v60, a61
    v_lshlrev_b32 v4, 16, v60
    v_and_b32 v5, 0xffff0000, v60
    v_fmac_f32 v42, v4, v23
    v_fmac_f32 v43, v5, v23
    v_fmac_f32 v50, v4, v39
    v_fmac_f32 v51, v5, v39
    v_accvgpr_read_b32 v60, a62
    v_lshlrev_b32 v4, 16, v60
    v_and_b32 v5, 0xffff0000, v60
    v_fmac_f32 v44, v4, v23
    v_fmac_f32 v45, v5, v23
    v_fmac_f32 v52, v4, v39
    v_fmac_f32 v53, v5, v39
    v_accvgpr_read_b32 v60, a63
    v_lshlrev_b32 v4, 16, v60
    v_and_b32 v5, 0xffff0000, v60
    v_fmac_f32 v46, v4, v23
    v_fmac_f32 v47, v5, v23
    v_fmac_f32 v54, v4, v39
    v_fmac_f32 v55, v5, v39
    v_lshlrev_b32 v7, 9, v2
    v_lshl_add_u32 v7, v1, 5, v7
    ds_write_b128 v7, v[40:43] offset:16384
    ds_write_b128 v7, v[44:47] offset:16400
    ds_write_b128 v7, v[48:51] offset:16640
    ds_write_b128 v7, v[52:55] offset:16656
    s_waitcnt lgkmcnt(0)
    v_mov_b32 v61, 88
    v_mov_b32 v62, 1
    s_mov_b64 exec, 1
    ds_add_u32 v61, v62
    s_mov_b64 exec, -1
SB_26:
    ds_read_b32 v62, v61
    s_waitcnt lgkmcnt(0)
    v_readfirstlane_b32 s90, v62
    s_cmp_ge_u32 s90, 4
    s_cbranch_scc1 SB_26d
    s_sleep 1
    s_branch SB_26
SB_26d:
    s_cmp_ge_u32 s3, 2
    s_cbranch_scc1 L_opB_sk1
    v_lshlrev_b32 v7, 2, v0
    ds_read_b32 v8, v7 offset:16384
    ds_read_b32 v9, v7 offset:16896
    ds_read_b32 v10, v7 offset:17408
    ds_read_b32 v11, v7 offset:17920
    ds_read_b32 v12, v7 offset:18432
    ds_read_b32 v13, v7 offset:18944
    ds_read_b32 v14, v7 offset:19456
    ds_read_b32 v15, v7 offset:19968
    ds_read_b32 v16, v7 offset:20480
    ds_read_b32 v17, v7 offset:20992
    ds_read_b32 v18, v7 offset:21504
    ds_read_b32 v19, v7 offset:22016
    ds_read_b32 v20, v7 offset:22528
    ds_read_b32 v21, v7 offset:23040
    ds_read_b32 v22, v7 offset:23552
    ds_read_b32 v23, v7 offset:24064
    ds_read_b32 v24, v7 offset:24576
    ds_read_b32 v25, v7 offset:25088
    ds_read_b32 v26, v7 offset:25600
    ds_read_b32 v27, v7 offset:26112
    ds_read_b32 v28, v7 offset:26624
    ds_read_b32 v29, v7 offset:27136
    ds_read_b32 v30, v7 offset:27648
    ds_read_b32 v31, v7 offset:28160
    ds_read_b32 v32, v7 offset:28672
    ds_read_b32 v33, v7 offset:29184
    ds_read_b32 v34, v7 offset:29696
    ds_read_b32 v35, v7 offset:30208
    ds_read_b32 v36, v7 offset:30720
    ds_read_b32 v37, v7 offset:31232
    ds_read_b32 v38, v7 offset:31744
    ds_read_b32 v39, v7 offset:32256
    s_waitcnt lgkmcnt(0)
    v_add_f32 v8, v8, v24
    v_add_f32 v9, v9, v25
    v_add_f32 v10, v10, v26
    v_add_f32 v11, v11, v27
    v_add_f32 v12, v12, v28
    v_add_f32 v13, v13, v29
    v_add_f32 v14, v14, v30
    v_add_f32 v15, v15, v31
    v_add_f32 v16, v16, v32
    v_add_f32 v17, v17, v33
    v_add_f32 v18, v18, v34
    v_add_f32 v19, v19, v35
    v_add_f32 v20, v20, v36
    v_add_f32 v21, v21, v37
    v_add_f32 v22, v22, v38
    v_add_f32 v23, v23, v39
    v_add_f32 v8, v8, v16
    v_add_f32 v9, v9, v17
    v_add_f32 v10, v10, v18
    v_add_f32 v11, v11, v19
    v_add_f32 v12, v12, v20
    v_add_f32 v13, v13, v21
    v_add_f32 v14, v14, v22
    v_add_f32 v15, v15, v23
    v_add_f32 v8, v8, v12
    v_add_f32 v9, v9, v13
    v_add_f32 v10, v10, v14
    v_add_f32 v11, v11, v15
    v_add_f32 v8, v8, v10
    v_add_f32 v9, v9, v11
    v_add_f32 v8, v8, v9
    s_add_u32 s54, s64, 9
    s_lshl_b32 s54, s54, 3
    s_add_u32 s55, s54, s65
    s_lshl_b32 s55, s55, 9
    s_add_u32 s55, s55, 10485760
    buffer_store_dword v8, v7, s[32:35], s55 offen sc1
    s_waitcnt vmcnt(0)
L_opB_sk1:
    s_waitcnt lgkmcnt(0)
    v_mov_b32 v61, 92
    v_mov_b32 v62, 1
    s_mov_b64 exec, 1
    ds_add_u32 v61, v62
    s_mov_b64 exec, -1
SB_27:
    ds_read_b32 v62, v61
    s_waitcnt lgkmcnt(0)
    v_readfirstlane_b32 s90, v62
    s_cmp_ge_u32 s90, 4
    s_cbranch_scc1 SB_27d
    s_sleep 1
    s_branch SB_27
SB_27d:
    s_cmp_lg_u32 s3, 0
    s_cbranch_scc1 L_end
    s_add_u32 s54, s64, 41
    s_lshl_b32 s54, s54, 2
    v_mov_b32 v8, 1
    v_mov_b32 v9, s54
    s_mov_b64 exec, 1
    buffer_atomic_add v8, v9, s[36:39], 0 offen sc0
    s_waitcnt vmcnt(0)
    s_mov_b64 exec, -1
    v_readfirstlane_b32 s55, v8
    s_cmp_lg_u32 s55, 7
    s_cbranch_scc1 L_end
    v_lshlrev_b32 v7, 2, v56
    s_add_u32 s54, s64, 9
    s_lshl_b32 s54, s54, 12
    s_add_u32 s54, s54, 10485760
    buffer_load_dword v8, v7, s[32:35], s54 offen offset:0 sc1
    buffer_load_dword v16, v7, s[32:35], s54 offen offset:256 sc1
    buffer_load_dword v9, v7, s[32:35], s54 offen offset:512 sc1
    buffer_load_dword v17, v7, s[32:35], s54 offen offset:768 sc1
    buffer_load_dword v10, v7, s[32:35], s54 offen offset:1024 sc1
    buffer_load_dword v18, v7, s[32:35], s54 offen offset:1280 sc1
    buffer_load_dword v11, v7, s[32:35], s54 offen offset:1536 sc1
    buffer_load_dword v19, v7, s[32:35], s54 offen offset:1792 sc1
    buffer_load_dword v12, v7, s[32:35], s54 offen offset:2048 sc1
    buffer_load_dword v20, v7, s[32:35], s54 offen offset:2304 sc1
    buffer_load_dword v13, v7, s[32:35], s54 offen offset:2560 sc1
    buffer_load_dword v21, v7, s[32:35], s54 offen offset:2816 sc1
    buffer_load_dword v14, v7, s[32:35], s54 offen offset:3072 sc1
    buffer_load_dword v22, v7, s[32:35], s54 offen offset:3328 sc1
    buffer_load_dword v15, v7, s[32:35], s54 offen offset:3584 sc1
    buffer_load_dword v23, v7, s[32:35], s54 offen offset:3840 sc1
    s_waitcnt vmcnt(0)
    v_add_f32 v8, v8, v12
    v_add_f32 v16, v16, v20
    v_add_f32 v9, v9, v13
    v_add_f32 v17, v17, v21
    v_add_f32 v10, v10, v14
    v_add_f32 v18, v18, v22
    v_add_f32 v11, v11, v15
    v_add_f32 v19, v19, v23
    v_add_f32 v8, v8, v10
    v_add_f32 v16, v16, v18
    v_add_f32 v9, v9, v11
    v_add_f32 v17, v17, v19
    v_add_f32 v8, v8, v9
    v_add_f32 v16, v16, v17
    v_cvt_pk_bf16_f32 v8, v8, v8
    v_cvt_pk_bf16_f32 v16, v16, v16
    s_lshl_b32 s54, s64, 6
    s_add_u32 s54, s54, 576
    v_add_u32 v4, s54, v56
    v_lshlrev_b32 v4, 1, v4
    buffer_store_short v8, v4, s[48:51], 0 offen
    buffer_store_short v16, v4, s[48:51], 0 offen offset:2304
    s_branch L_end
L_h_b:
    s_mov_b32 s40, s14
    s_mov_b32 s41, s15
    s_mov_b32 s42, 2304
    s_mov_b32 s43, 0x00020000
    s_mov_b32 s44, s18
    s_mov_b32 s45, s19
    s_mov_b32 s46, 4718592
    s_mov_b32 s47, 0x00020000
    s_mov_b32 s48, s20
    s_mov_b32 s49, s21
    s_mov_b32 s50, 4194304
    s_mov_b32 s51, 0x00020000
    v_and_b32 v1, 15, v0
    v_lshrrev_b32 v2, 4, v0
    v_lshlrev_b32 v3, 4, v1
    v_lshl_add_u32 v3, v2, 13, v3
    v_lshlrev_b32 v4, 4, v0
    buffer_load_dwordx4 v[8:11], v4, s[40:43], 0 offen
    s_lshl_b32 s52, s61, 8
    s_add_u32 s54, s52, 0
    buffer_load_dwordx4 v[64:67], v3, s[44:47], s54 offen
    s_add_u32 s54, s52, 131072
    buffer_load_dwordx4 v[68:71], v3, s[44:47], s54 offen
    s_add_u32 s54, s52, 262144
    buffer_load_dwordx4 v[72:75], v3, s[44:47], s54 offen
    s_add_u32 s54, s52, 393216
    buffer_load_dwordx4 v[76:79], v3, s[44:47], s54 offen
    s_add_u32 s54, s52, 524288
    buffer_load_dwordx4 v[80:83], v3, s[44:47], s54 offen
    s_add_u32 s54, s52, 655360
    buffer_load_dwordx4 v[84:87], v3, s[44:47], s54 offen
    s_add_u32 s54, s52, 786432
    buffer_load_dwordx4 v[88:91], v3, s[44:47], s54 offen
    s_add_u32 s54, s52, 917504
    buffer_load_dwordx4 v[92:95], v3, s[44:47], s54 offen
    s_add_u32 s54, s52, 1048576
    buffer_load_dwordx4 v[96:99], v3, s[44:47], s54 offen
    s_add_u32 s54, s52, 1179648
    buffer_load_dwordx4 v[100:103], v3, s[44:47], s54 offen
    s_add_u32 s54, s52, 1310720
    buffer_load_dwordx4 v[104:107], v3, s[44:47], s54 offen
    s_add_u32 s54, s52, 1441792
    buffer_load_dwordx4 v[108:111], v3, s[44:47], s54 offen
    s_lshl_b32 s55, s62, 20
    s_add_u32 s55, s55, s52
    s_add_u32 s54, s55, 0
    buffer_load_dwordx4 a[64:67], v3, s[48:51], s54 offen
    s_add_u32 s54, s55, 131072
    buffer_load_dwordx4 a[68:71], v3, s[48:51], s54 offen
    s_add_u32 s54, s55, 262144
    buffer_load_dwordx4 a[72:75], v3, s[48:51], s54 offen
    s_add_u32 s54, s55, 393216
    buffer_load_dwordx4 a[76:79], v3, s[48:51], s54 offen
    s_add_u32 s54, s55, 524288
    buffer_load_dwordx4 a[80:83], v3, s[48:51], s54 offen
    s_add_u32 s54, s55, 655360
    buffer_load_dwordx4 a[84:87], v3, s[48:51], s54 offen
    s_add_u32 s54, s55, 786432
    buffer_load_dwordx4 a[88:91], v3, s[48:51], s54 offen
    s_add_u32 s54, s55, 917504
    buffer_load_dwordx4 a[92:95], v3, s[48:51], s54 offen
    s_setprio 0
    s_cmp_lg_u32 s3, 0
    s_cbranch_scc1 EP_28
    s_waitcnt vmcnt(21)
    v_readfirstlane_b32 s89, v122
    s_cmp_eq_u32 s89, 0
    s_cselect_b32 s89, s92, s89
    v_mov_b32 v122, 20
    v_mov_b32 v123, s89
    ds_write_b32 v122, v123
EP_28:
    s_waitcnt vmcnt(20)
    v_lshlrev_b32 v12, 16, v8
    v_and_b32 v13, 0xffff0000, v8
    v_lshlrev_b32 v14, 16, v9
    v_and_b32 v15, 0xffff0000, v9
    v_lshlrev_b32 v16, 16, v10
    v_and_b32 v17, 0xffff0000, v10
    v_lshlrev_b32 v18, 16, v11
    v_and_b32 v19, 0xffff0000, v11
    v_lshlrev_b32 v4, 5, v0
    v_cmp_gt_u32 vcc, 144, v0
    s_and_saveexec_b64 s[56:57], vcc
    ds_write_b128 v4, v[12:15] offset:24576
    ds_write_b128 v4, v[16:19] offset:24592
    s_mov_b64 exec, s[56:57]
    s_waitcnt lgkmcnt(0)
    v_mov_b32 v120, 96
    v_mov_b32 v121, 1
    s_mov_b64 exec, 1
    ds_add_u32 v120, v121
    s_mov_b64 exec, -1
SB_29:
    ds_read_b32 v121, v120
    s_waitcnt lgkmcnt(0)
    v_readfirstlane_b32 s90, v121
    s_cmp_ge_u32 s90, 4
    s_cbranch_scc1 SB_29d
    s_sleep 1
    s_branch SB_29
SB_29d:
    v_mov_b32 v24, 0
    v_mov_b32 v25, 0
    v_mov_b32 v26, 0
    v_mov_b32 v27, 0
    v_mov_b32 v28, 0
    v_mov_b32 v29, 0
    v_mov_b32 v30, 0
    v_mov_b32 v31, 0
    v_mov_b32 v32, 0
    v_mov_b32 v33, 0
    v_mov_b32 v34, 0
    v_mov_b32 v35, 0
    v_mov_b32 v36, 0
    v_mov_b32 v37, 0
    v_mov_b32 v38, 0
    v_mov_b32 v39, 0
    v_lshlrev_b32 v5, 2, v2
    ds_read_b32 v40, v5 offset:24576
    ds_read_b32 v52, v5 offset:26880
    ds_read_b32 v41, v5 offset:24640
    ds_read_b32 v53, v5 offset:26944
    ds_read_b32 v42, v5 offset:24704
    ds_read_b32 v54, v5 offset:27008
    ds_read_b32 v43, v5 offset:24768
    ds_read_b32 v55, v5 offset:27072
    ds_read_b32 v44, v5 offset:24832
    ds_read_b32 v56, v5 offset:27136
    ds_read_b32 v45, v5 offset:24896
    ds_read_b32 v57, v5 offset:27200
    ds_read_b32 v46, v5 offset:24960
    ds_read_b32 v58, v5 offset:27264
    ds_read_b32 v47, v5 offset:25024
    ds_read_b32 v59, v5 offset:27328
    ds_read_b32 v48, v5 offset:25088
    ds_read_b32 v60, v5 offset:27392
    ds_read_b32 v49, v5 offset:25152
    ds_read_b32 v61, v5 offset:27456
    ds_read_b32 v50, v5 offset:25216
    ds_read_b32 v62, v5 offset:27520
    ds_read_b32 v51, v5 offset:25280
    ds_read_b32 v63, v5 offset:27584
    s_waitcnt vmcnt(8) lgkmcnt(0)
    v_lshlrev_b32 v6, 16, v64
    v_and_b32 v7, 0xffff0000, v64
    v_fmac_f32 v24, v6, v40
    v_fmac_f32 v25, v7, v40
    v_fmac_f32 v32, v6, v52
    v_fmac_f32 v33, v7, v52
    v_lshlrev_b32 v6, 16, v65
    v_and_b32 v7, 0xffff0000, v65
    v_fmac_f32 v26, v6, v40
    v_fmac_f32 v27, v7, v40
    v_fmac_f32 v34, v6, v52
    v_fmac_f32 v35, v7, v52
    v_lshlrev_b32 v6, 16, v66
    v_and_b32 v7, 0xffff0000, v66
    v_fmac_f32 v28, v6, v40
    v_fmac_f32 v29, v7, v40
    v_fmac_f32 v36, v6, v52
    v_fmac_f32 v37, v7, v52
    v_lshlrev_b32 v6, 16, v67
    v_and_b32 v7, 0xffff0000, v67
    v_fmac_f32 v30, v6, v40
    v_fmac_f32 v31, v7, v40
    v_fmac_f32 v38, v6, v52
    v_fmac_f32 v39, v7, v52
    s_add_u32 s54, s52, 1572864
    buffer_load_dwordx4 v[64:67], v3, s[44:47], s54 offen
    v_lshlrev_b32 v6, 16, v68
    v_and_b32 v7, 0xffff0000, v68
    v_fmac_f32 v24, v6, v41
    v_fmac_f32 v25, v7, v41
    v_fmac_f32 v32, v6, v53
    v_fmac_f32 v33, v7, v53
    v_lshlrev_b32 v6, 16, v69
    v_and_b32 v7, 0xffff0000, v69
    v_fmac_f32 v26, v6, v41
    v_fmac_f32 v27, v7, v41
    v_fmac_f32 v34, v6, v53
    v_fmac_f32 v35, v7, v53
    v_lshlrev_b32 v6, 16, v70
    v_and_b32 v7, 0xffff0000, v70
    v_fmac_f32 v28, v6, v41
    v_fmac_f32 v29, v7, v41
    v_fmac_f32 v36, v6, v53
    v_fmac_f32 v37, v7, v53
    v_lshlrev_b32 v6, 16, v71
    v_and_b32 v7, 0xffff0000, v71
    v_fmac_f32 v30, v6, v41
    v_fmac_f32 v31, v7, v41
    v_fmac_f32 v38, v6, v53
    v_fmac_f32 v39, v7, v53
    s_add_u32 s54, s52, 1703936
    buffer_load_dwordx4 v[68:71], v3, s[44:47], s54 offen
    v_lshlrev_b32 v6, 16, v72
    v_and_b32 v7, 0xffff0000, v72
    v_fmac_f32 v24, v6, v42
    v_fmac_f32 v25, v7, v42
    v_fmac_f32 v32, v6, v54
    v_fmac_f32 v33, v7, v54
    v_lshlrev_b32 v6, 16, v73
    v_and_b32 v7, 0xffff0000, v73
    v_fmac_f32 v26, v6, v42
    v_fmac_f32 v27, v7, v42
    v_fmac_f32 v34, v6, v54
    v_fmac_f32 v35, v7, v54
    v_lshlrev_b32 v6, 16, v74
    v_and_b32 v7, 0xffff0000, v74
    v_fmac_f32 v28, v6, v42
    v_fmac_f32 v29, v7, v42
    v_fmac_f32 v36, v6, v54
    v_fmac_f32 v37, v7, v54
    v_lshlrev_b32 v6, 16, v75
    v_and_b32 v7, 0xffff0000, v75
    v_fmac_f32 v30, v6, v42
    v_fmac_f32 v31, v7, v42
    v_fmac_f32 v38, v6, v54
    v_fmac_f32 v39, v7, v54
    s_add_u32 s54, s52, 1835008
    buffer_load_dwordx4 v[72:75], v3, s[44:47], s54 offen
    v_lshlrev_b32 v6, 16, v76
    v_and_b32 v7, 0xffff0000, v76
    v_fmac_f32 v24, v6, v43
    v_fmac_f32 v25, v7, v43
    v_fmac_f32 v32, v6, v55
    v_fmac_f32 v33, v7, v55
    v_lshlrev_b32 v6, 16, v77
    v_and_b32 v7, 0xffff0000, v77
    v_fmac_f32 v26, v6, v43
    v_fmac_f32 v27, v7, v43
    v_fmac_f32 v34, v6, v55
    v_fmac_f32 v35, v7, v55
    v_lshlrev_b32 v6, 16, v78
    v_and_b32 v7, 0xffff0000, v78
    v_fmac_f32 v28, v6, v43
    v_fmac_f32 v29, v7, v43
    v_fmac_f32 v36, v6, v55
    v_fmac_f32 v37, v7, v55
    v_lshlrev_b32 v6, 16, v79
    v_and_b32 v7, 0xffff0000, v79
    v_fmac_f32 v30, v6, v43
    v_fmac_f32 v31, v7, v43
    v_fmac_f32 v38, v6, v55
    v_fmac_f32 v39, v7, v55
    s_add_u32 s54, s52, 1966080
    buffer_load_dwordx4 v[76:79], v3, s[44:47], s54 offen
    v_lshlrev_b32 v6, 16, v80
    v_and_b32 v7, 0xffff0000, v80
    v_fmac_f32 v24, v6, v44
    v_fmac_f32 v25, v7, v44
    v_fmac_f32 v32, v6, v56
    v_fmac_f32 v33, v7, v56
    v_lshlrev_b32 v6, 16, v81
    v_and_b32 v7, 0xffff0000, v81
    v_fmac_f32 v26, v6, v44
    v_fmac_f32 v27, v7, v44
    v_fmac_f32 v34, v6, v56
    v_fmac_f32 v35, v7, v56
    v_lshlrev_b32 v6, 16, v82
    v_and_b32 v7, 0xffff0000, v82
    v_fmac_f32 v28, v6, v44
    v_fmac_f32 v29, v7, v44
    v_fmac_f32 v36, v6, v56
    v_fmac_f32 v37, v7, v56
    v_lshlrev_b32 v6, 16, v83
    v_and_b32 v7, 0xffff0000, v83
    v_fmac_f32 v30, v6, v44
    v_fmac_f32 v31, v7, v44
    v_fmac_f32 v38, v6, v56
    v_fmac_f32 v39, v7, v56
    s_add_u32 s54, s52, 2097152
    buffer_load_dwordx4 v[80:83], v3, s[44:47], s54 offen
    v_lshlrev_b32 v6, 16, v84
    v_and_b32 v7, 0xffff0000, v84
    v_fmac_f32 v24, v6, v45
    v_fmac_f32 v25, v7, v45
    v_fmac_f32 v32, v6, v57
    v_fmac_f32 v33, v7, v57
    v_lshlrev_b32 v6, 16, v85
    v_and_b32 v7, 0xffff0000, v85
    v_fmac_f32 v26, v6, v45
    v_fmac_f32 v27, v7, v45
    v_fmac_f32 v34, v6, v57
    v_fmac_f32 v35, v7, v57
    v_lshlrev_b32 v6, 16, v86
    v_and_b32 v7, 0xffff0000, v86
    v_fmac_f32 v28, v6, v45
    v_fmac_f32 v29, v7, v45
    v_fmac_f32 v36, v6, v57
    v_fmac_f32 v37, v7, v57
    v_lshlrev_b32 v6, 16, v87
    v_and_b32 v7, 0xffff0000, v87
    v_fmac_f32 v30, v6, v45
    v_fmac_f32 v31, v7, v45
    v_fmac_f32 v38, v6, v57
    v_fmac_f32 v39, v7, v57
    s_add_u32 s54, s52, 2228224
    buffer_load_dwordx4 v[84:87], v3, s[44:47], s54 offen
    v_lshlrev_b32 v6, 16, v88
    v_and_b32 v7, 0xffff0000, v88
    v_fmac_f32 v24, v6, v46
    v_fmac_f32 v25, v7, v46
    v_fmac_f32 v32, v6, v58
    v_fmac_f32 v33, v7, v58
    v_lshlrev_b32 v6, 16, v89
    v_and_b32 v7, 0xffff0000, v89
    v_fmac_f32 v26, v6, v46
    v_fmac_f32 v27, v7, v46
    v_fmac_f32 v34, v6, v58
    v_fmac_f32 v35, v7, v58
    v_lshlrev_b32 v6, 16, v90
    v_and_b32 v7, 0xffff0000, v90
    v_fmac_f32 v28, v6, v46
    v_fmac_f32 v29, v7, v46
    v_fmac_f32 v36, v6, v58
    v_fmac_f32 v37, v7, v58
    v_lshlrev_b32 v6, 16, v91
    v_and_b32 v7, 0xffff0000, v91
    v_fmac_f32 v30, v6, v46
    v_fmac_f32 v31, v7, v46
    v_fmac_f32 v38, v6, v58
    v_fmac_f32 v39, v7, v58
    s_add_u32 s54, s52, 2359296
    buffer_load_dwordx4 v[88:91], v3, s[44:47], s54 offen
    v_lshlrev_b32 v6, 16, v92
    v_and_b32 v7, 0xffff0000, v92
    v_fmac_f32 v24, v6, v47
    v_fmac_f32 v25, v7, v47
    v_fmac_f32 v32, v6, v59
    v_fmac_f32 v33, v7, v59
    v_lshlrev_b32 v6, 16, v93
    v_and_b32 v7, 0xffff0000, v93
    v_fmac_f32 v26, v6, v47
    v_fmac_f32 v27, v7, v47
    v_fmac_f32 v34, v6, v59
    v_fmac_f32 v35, v7, v59
    v_lshlrev_b32 v6, 16, v94
    v_and_b32 v7, 0xffff0000, v94
    v_fmac_f32 v28, v6, v47
    v_fmac_f32 v29, v7, v47
    v_fmac_f32 v36, v6, v59
    v_fmac_f32 v37, v7, v59
    v_lshlrev_b32 v6, 16, v95
    v_and_b32 v7, 0xffff0000, v95
    v_fmac_f32 v30, v6, v47
    v_fmac_f32 v31, v7, v47
    v_fmac_f32 v38, v6, v59
    v_fmac_f32 v39, v7, v59
    s_add_u32 s54, s52, 2490368
    buffer_load_dwordx4 v[92:95], v3, s[44:47], s54 offen
    v_lshlrev_b32 v6, 16, v96
    v_and_b32 v7, 0xffff0000, v96
    v_fmac_f32 v24, v6, v48
    v_fmac_f32 v25, v7, v48
    v_fmac_f32 v32, v6, v60
    v_fmac_f32 v33, v7, v60
    v_lshlrev_b32 v6, 16, v97
    v_and_b32 v7, 0xffff0000, v97
    v_fmac_f32 v26, v6, v48
    v_fmac_f32 v27, v7, v48
    v_fmac_f32 v34, v6, v60
    v_fmac_f32 v35, v7, v60
    v_lshlrev_b32 v6, 16, v98
    v_and_b32 v7, 0xffff0000, v98
    v_fmac_f32 v28, v6, v48
    v_fmac_f32 v29, v7, v48
    v_fmac_f32 v36, v6, v60
    v_fmac_f32 v37, v7, v60
    v_lshlrev_b32 v6, 16, v99
    v_and_b32 v7, 0xffff0000, v99
    v_fmac_f32 v30, v6, v48
    v_fmac_f32 v31, v7, v48
    v_fmac_f32 v38, v6, v60
    v_fmac_f32 v39, v7, v60
    s_add_u32 s54, s52, 2621440
    buffer_load_dwordx4 v[96:99], v3, s[44:47], s54 offen
    v_lshlrev_b32 v6, 16, v100
    v_and_b32 v7, 0xffff0000, v100
    v_fmac_f32 v24, v6, v49
    v_fmac_f32 v25, v7, v49
    v_fmac_f32 v32, v6, v61
    v_fmac_f32 v33, v7, v61
    v_lshlrev_b32 v6, 16, v101
    v_and_b32 v7, 0xffff0000, v101
    v_fmac_f32 v26, v6, v49
    v_fmac_f32 v27, v7, v49
    v_fmac_f32 v34, v6, v61
    v_fmac_f32 v35, v7, v61
    v_lshlrev_b32 v6, 16, v102
    v_and_b32 v7, 0xffff0000, v102
    v_fmac_f32 v28, v6, v49
    v_fmac_f32 v29, v7, v49
    v_fmac_f32 v36, v6, v61
    v_fmac_f32 v37, v7, v61
    v_lshlrev_b32 v6, 16, v103
    v_and_b32 v7, 0xffff0000, v103
    v_fmac_f32 v30, v6, v49
    v_fmac_f32 v31, v7, v49
    v_fmac_f32 v38, v6, v61
    v_fmac_f32 v39, v7, v61
    s_add_u32 s54, s52, 2752512
    buffer_load_dwordx4 v[100:103], v3, s[44:47], s54 offen
    v_lshlrev_b32 v6, 16, v104
    v_and_b32 v7, 0xffff0000, v104
    v_fmac_f32 v24, v6, v50
    v_fmac_f32 v25, v7, v50
    v_fmac_f32 v32, v6, v62
    v_fmac_f32 v33, v7, v62
    v_lshlrev_b32 v6, 16, v105
    v_and_b32 v7, 0xffff0000, v105
    v_fmac_f32 v26, v6, v50
    v_fmac_f32 v27, v7, v50
    v_fmac_f32 v34, v6, v62
    v_fmac_f32 v35, v7, v62
    v_lshlrev_b32 v6, 16, v106
    v_and_b32 v7, 0xffff0000, v106
    v_fmac_f32 v28, v6, v50
    v_fmac_f32 v29, v7, v50
    v_fmac_f32 v36, v6, v62
    v_fmac_f32 v37, v7, v62
    v_lshlrev_b32 v6, 16, v107
    v_and_b32 v7, 0xffff0000, v107
    v_fmac_f32 v30, v6, v50
    v_fmac_f32 v31, v7, v50
    v_fmac_f32 v38, v6, v62
    v_fmac_f32 v39, v7, v62
    s_add_u32 s54, s52, 2883584
    buffer_load_dwordx4 v[104:107], v3, s[44:47], s54 offen
    v_lshlrev_b32 v6, 16, v108
    v_and_b32 v7, 0xffff0000, v108
    v_fmac_f32 v24, v6, v51
    v_fmac_f32 v25, v7, v51
    v_fmac_f32 v32, v6, v63
    v_fmac_f32 v33, v7, v63
    v_lshlrev_b32 v6, 16, v109
    v_and_b32 v7, 0xffff0000, v109
    v_fmac_f32 v26, v6, v51
    v_fmac_f32 v27, v7, v51
    v_fmac_f32 v34, v6, v63
    v_fmac_f32 v35, v7, v63
    v_lshlrev_b32 v6, 16, v110
    v_and_b32 v7, 0xffff0000, v110
    v_fmac_f32 v28, v6, v51
    v_fmac_f32 v29, v7, v51
    v_fmac_f32 v36, v6, v63
    v_fmac_f32 v37, v7, v63
    v_lshlrev_b32 v6, 16, v111
    v_and_b32 v7, 0xffff0000, v111
    v_fmac_f32 v30, v6, v51
    v_fmac_f32 v31, v7, v51
    v_fmac_f32 v38, v6, v63
    v_fmac_f32 v39, v7, v63
    s_add_u32 s54, s52, 3014656
    buffer_load_dwordx4 v[108:111], v3, s[44:47], s54 offen
    ds_read_b32 v40, v5 offset:25344
    ds_read_b32 v52, v5 offset:27648
    ds_read_b32 v41, v5 offset:25408
    ds_read_b32 v53, v5 offset:27712
    ds_read_b32 v42, v5 offset:25472
    ds_read_b32 v54, v5 offset:27776
    ds_read_b32 v43, v5 offset:25536
    ds_read_b32 v55, v5 offset:27840
    ds_read_b32 v44, v5 offset:25600
    ds_read_b32 v56, v5 offset:27904
    ds_read_b32 v45, v5 offset:25664
    ds_read_b32 v57, v5 offset:27968
    ds_read_b32 v46, v5 offset:25728
    ds_read_b32 v58, v5 offset:28032
    ds_read_b32 v47, v5 offset:25792
    ds_read_b32 v59, v5 offset:28096
    ds_read_b32 v48, v5 offset:25856
    ds_read_b32 v60, v5 offset:28160
    ds_read_b32 v49, v5 offset:25920
    ds_read_b32 v61, v5 offset:28224
    ds_read_b32 v50, v5 offset:25984
    ds_read_b32 v62, v5 offset:28288
    ds_read_b32 v51, v5 offset:26048
    ds_read_b32 v63, v5 offset:28352
    s_waitcnt vmcnt(0) lgkmcnt(0)
    v_lshlrev_b32 v6, 16, v64
    v_and_b32 v7, 0xffff0000, v64
    v_fmac_f32 v24, v6, v40
    v_fmac_f32 v25, v7, v40
    v_fmac_f32 v32, v6, v52
    v_fmac_f32 v33, v7, v52
    v_lshlrev_b32 v6, 16, v65
    v_and_b32 v7, 0xffff0000, v65
    v_fmac_f32 v26, v6, v40
    v_fmac_f32 v27, v7, v40
    v_fmac_f32 v34, v6, v52
    v_fmac_f32 v35, v7, v52
    v_lshlrev_b32 v6, 16, v66
    v_and_b32 v7, 0xffff0000, v66
    v_fmac_f32 v28, v6, v40
    v_fmac_f32 v29, v7, v40
    v_fmac_f32 v36, v6, v52
    v_fmac_f32 v37, v7, v52
    v_lshlrev_b32 v6, 16, v67
    v_and_b32 v7, 0xffff0000, v67
    v_fmac_f32 v30, v6, v40
    v_fmac_f32 v31, v7, v40
    v_fmac_f32 v38, v6, v52
    v_fmac_f32 v39, v7, v52
    s_add_u32 s54, s52, 3145728
    buffer_load_dwordx4 v[64:67], v3, s[44:47], s54 offen
    v_lshlrev_b32 v6, 16, v68
    v_and_b32 v7, 0xffff0000, v68
    v_fmac_f32 v24, v6, v41
    v_fmac_f32 v25, v7, v41
    v_fmac_f32 v32, v6, v53
    v_fmac_f32 v33, v7, v53
    v_lshlrev_b32 v6, 16, v69
    v_and_b32 v7, 0xffff0000, v69
    v_fmac_f32 v26, v6, v41
    v_fmac_f32 v27, v7, v41
    v_fmac_f32 v34, v6, v53
    v_fmac_f32 v35, v7, v53
    v_lshlrev_b32 v6, 16, v70
    v_and_b32 v7, 0xffff0000, v70
    v_fmac_f32 v28, v6, v41
    v_fmac_f32 v29, v7, v41
    v_fmac_f32 v36, v6, v53
    v_fmac_f32 v37, v7, v53
    v_lshlrev_b32 v6, 16, v71
    v_and_b32 v7, 0xffff0000, v71
    v_fmac_f32 v30, v6, v41
    v_fmac_f32 v31, v7, v41
    v_fmac_f32 v38, v6, v53
    v_fmac_f32 v39, v7, v53
    s_add_u32 s54, s52, 3276800
    buffer_load_dwordx4 v[68:71], v3, s[44:47], s54 offen
    v_lshlrev_b32 v6, 16, v72
    v_and_b32 v7, 0xffff0000, v72
    v_fmac_f32 v24, v6, v42
    v_fmac_f32 v25, v7, v42
    v_fmac_f32 v32, v6, v54
    v_fmac_f32 v33, v7, v54
    v_lshlrev_b32 v6, 16, v73
    v_and_b32 v7, 0xffff0000, v73
    v_fmac_f32 v26, v6, v42
    v_fmac_f32 v27, v7, v42
    v_fmac_f32 v34, v6, v54
    v_fmac_f32 v35, v7, v54
    v_lshlrev_b32 v6, 16, v74
    v_and_b32 v7, 0xffff0000, v74
    v_fmac_f32 v28, v6, v42
    v_fmac_f32 v29, v7, v42
    v_fmac_f32 v36, v6, v54
    v_fmac_f32 v37, v7, v54
    v_lshlrev_b32 v6, 16, v75
    v_and_b32 v7, 0xffff0000, v75
    v_fmac_f32 v30, v6, v42
    v_fmac_f32 v31, v7, v42
    v_fmac_f32 v38, v6, v54
    v_fmac_f32 v39, v7, v54
    s_add_u32 s54, s52, 3407872
    buffer_load_dwordx4 v[72:75], v3, s[44:47], s54 offen
    v_lshlrev_b32 v6, 16, v76
    v_and_b32 v7, 0xffff0000, v76
    v_fmac_f32 v24, v6, v43
    v_fmac_f32 v25, v7, v43
    v_fmac_f32 v32, v6, v55
    v_fmac_f32 v33, v7, v55
    v_lshlrev_b32 v6, 16, v77
    v_and_b32 v7, 0xffff0000, v77
    v_fmac_f32 v26, v6, v43
    v_fmac_f32 v27, v7, v43
    v_fmac_f32 v34, v6, v55
    v_fmac_f32 v35, v7, v55
    v_lshlrev_b32 v6, 16, v78
    v_and_b32 v7, 0xffff0000, v78
    v_fmac_f32 v28, v6, v43
    v_fmac_f32 v29, v7, v43
    v_fmac_f32 v36, v6, v55
    v_fmac_f32 v37, v7, v55
    v_lshlrev_b32 v6, 16, v79
    v_and_b32 v7, 0xffff0000, v79
    v_fmac_f32 v30, v6, v43
    v_fmac_f32 v31, v7, v43
    v_fmac_f32 v38, v6, v55
    v_fmac_f32 v39, v7, v55
    s_add_u32 s54, s52, 3538944
    buffer_load_dwordx4 v[76:79], v3, s[44:47], s54 offen
    v_lshlrev_b32 v6, 16, v80
    v_and_b32 v7, 0xffff0000, v80
    v_fmac_f32 v24, v6, v44
    v_fmac_f32 v25, v7, v44
    v_fmac_f32 v32, v6, v56
    v_fmac_f32 v33, v7, v56
    v_lshlrev_b32 v6, 16, v81
    v_and_b32 v7, 0xffff0000, v81
    v_fmac_f32 v26, v6, v44
    v_fmac_f32 v27, v7, v44
    v_fmac_f32 v34, v6, v56
    v_fmac_f32 v35, v7, v56
    v_lshlrev_b32 v6, 16, v82
    v_and_b32 v7, 0xffff0000, v82
    v_fmac_f32 v28, v6, v44
    v_fmac_f32 v29, v7, v44
    v_fmac_f32 v36, v6, v56
    v_fmac_f32 v37, v7, v56
    v_lshlrev_b32 v6, 16, v83
    v_and_b32 v7, 0xffff0000, v83
    v_fmac_f32 v30, v6, v44
    v_fmac_f32 v31, v7, v44
    v_fmac_f32 v38, v6, v56
    v_fmac_f32 v39, v7, v56
    s_add_u32 s54, s52, 3670016
    buffer_load_dwordx4 v[80:83], v3, s[44:47], s54 offen
    v_lshlrev_b32 v6, 16, v84
    v_and_b32 v7, 0xffff0000, v84
    v_fmac_f32 v24, v6, v45
    v_fmac_f32 v25, v7, v45
    v_fmac_f32 v32, v6, v57
    v_fmac_f32 v33, v7, v57
    v_lshlrev_b32 v6, 16, v85
    v_and_b32 v7, 0xffff0000, v85
    v_fmac_f32 v26, v6, v45
    v_fmac_f32 v27, v7, v45
    v_fmac_f32 v34, v6, v57
    v_fmac_f32 v35, v7, v57
    v_lshlrev_b32 v6, 16, v86
    v_and_b32 v7, 0xffff0000, v86
    v_fmac_f32 v28, v6, v45
    v_fmac_f32 v29, v7, v45
    v_fmac_f32 v36, v6, v57
    v_fmac_f32 v37, v7, v57
    v_lshlrev_b32 v6, 16, v87
    v_and_b32 v7, 0xffff0000, v87
    v_fmac_f32 v30, v6, v45
    v_fmac_f32 v31, v7, v45
    v_fmac_f32 v38, v6, v57
    v_fmac_f32 v39, v7, v57
    s_add_u32 s54, s52, 3801088
    buffer_load_dwordx4 v[84:87], v3, s[44:47], s54 offen
    v_lshlrev_b32 v6, 16, v88
    v_and_b32 v7, 0xffff0000, v88
    v_fmac_f32 v24, v6, v46
    v_fmac_f32 v25, v7, v46
    v_fmac_f32 v32, v6, v58
    v_fmac_f32 v33, v7, v58
    v_lshlrev_b32 v6, 16, v89
    v_and_b32 v7, 0xffff0000, v89
    v_fmac_f32 v26, v6, v46
    v_fmac_f32 v27, v7, v46
    v_fmac_f32 v34, v6, v58
    v_fmac_f32 v35, v7, v58
    v_lshlrev_b32 v6, 16, v90
    v_and_b32 v7, 0xffff0000, v90
    v_fmac_f32 v28, v6, v46
    v_fmac_f32 v29, v7, v46
    v_fmac_f32 v36, v6, v58
    v_fmac_f32 v37, v7, v58
    v_lshlrev_b32 v6, 16, v91
    v_and_b32 v7, 0xffff0000, v91
    v_fmac_f32 v30, v6, v46
    v_fmac_f32 v31, v7, v46
    v_fmac_f32 v38, v6, v58
    v_fmac_f32 v39, v7, v58
    s_add_u32 s54, s52, 3932160
    buffer_load_dwordx4 v[88:91], v3, s[44:47], s54 offen
    v_lshlrev_b32 v6, 16, v92
    v_and_b32 v7, 0xffff0000, v92
    v_fmac_f32 v24, v6, v47
    v_fmac_f32 v25, v7, v47
    v_fmac_f32 v32, v6, v59
    v_fmac_f32 v33, v7, v59
    v_lshlrev_b32 v6, 16, v93
    v_and_b32 v7, 0xffff0000, v93
    v_fmac_f32 v26, v6, v47
    v_fmac_f32 v27, v7, v47
    v_fmac_f32 v34, v6, v59
    v_fmac_f32 v35, v7, v59
    v_lshlrev_b32 v6, 16, v94
    v_and_b32 v7, 0xffff0000, v94
    v_fmac_f32 v28, v6, v47
    v_fmac_f32 v29, v7, v47
    v_fmac_f32 v36, v6, v59
    v_fmac_f32 v37, v7, v59
    v_lshlrev_b32 v6, 16, v95
    v_and_b32 v7, 0xffff0000, v95
    v_fmac_f32 v30, v6, v47
    v_fmac_f32 v31, v7, v47
    v_fmac_f32 v38, v6, v59
    v_fmac_f32 v39, v7, v59
    s_add_u32 s54, s52, 4063232
    buffer_load_dwordx4 v[92:95], v3, s[44:47], s54 offen
    v_lshlrev_b32 v6, 16, v96
    v_and_b32 v7, 0xffff0000, v96
    v_fmac_f32 v24, v6, v48
    v_fmac_f32 v25, v7, v48
    v_fmac_f32 v32, v6, v60
    v_fmac_f32 v33, v7, v60
    v_lshlrev_b32 v6, 16, v97
    v_and_b32 v7, 0xffff0000, v97
    v_fmac_f32 v26, v6, v48
    v_fmac_f32 v27, v7, v48
    v_fmac_f32 v34, v6, v60
    v_fmac_f32 v35, v7, v60
    v_lshlrev_b32 v6, 16, v98
    v_and_b32 v7, 0xffff0000, v98
    v_fmac_f32 v28, v6, v48
    v_fmac_f32 v29, v7, v48
    v_fmac_f32 v36, v6, v60
    v_fmac_f32 v37, v7, v60
    v_lshlrev_b32 v6, 16, v99
    v_and_b32 v7, 0xffff0000, v99
    v_fmac_f32 v30, v6, v48
    v_fmac_f32 v31, v7, v48
    v_fmac_f32 v38, v6, v60
    v_fmac_f32 v39, v7, v60
    s_add_u32 s54, s52, 4194304
    buffer_load_dwordx4 v[96:99], v3, s[44:47], s54 offen
    v_lshlrev_b32 v6, 16, v100
    v_and_b32 v7, 0xffff0000, v100
    v_fmac_f32 v24, v6, v49
    v_fmac_f32 v25, v7, v49
    v_fmac_f32 v32, v6, v61
    v_fmac_f32 v33, v7, v61
    v_lshlrev_b32 v6, 16, v101
    v_and_b32 v7, 0xffff0000, v101
    v_fmac_f32 v26, v6, v49
    v_fmac_f32 v27, v7, v49
    v_fmac_f32 v34, v6, v61
    v_fmac_f32 v35, v7, v61
    v_lshlrev_b32 v6, 16, v102
    v_and_b32 v7, 0xffff0000, v102
    v_fmac_f32 v28, v6, v49
    v_fmac_f32 v29, v7, v49
    v_fmac_f32 v36, v6, v61
    v_fmac_f32 v37, v7, v61
    v_lshlrev_b32 v6, 16, v103
    v_and_b32 v7, 0xffff0000, v103
    v_fmac_f32 v30, v6, v49
    v_fmac_f32 v31, v7, v49
    v_fmac_f32 v38, v6, v61
    v_fmac_f32 v39, v7, v61
    s_add_u32 s54, s52, 4325376
    buffer_load_dwordx4 v[100:103], v3, s[44:47], s54 offen
    v_lshlrev_b32 v6, 16, v104
    v_and_b32 v7, 0xffff0000, v104
    v_fmac_f32 v24, v6, v50
    v_fmac_f32 v25, v7, v50
    v_fmac_f32 v32, v6, v62
    v_fmac_f32 v33, v7, v62
    v_lshlrev_b32 v6, 16, v105
    v_and_b32 v7, 0xffff0000, v105
    v_fmac_f32 v26, v6, v50
    v_fmac_f32 v27, v7, v50
    v_fmac_f32 v34, v6, v62
    v_fmac_f32 v35, v7, v62
    v_lshlrev_b32 v6, 16, v106
    v_and_b32 v7, 0xffff0000, v106
    v_fmac_f32 v28, v6, v50
    v_fmac_f32 v29, v7, v50
    v_fmac_f32 v36, v6, v62
    v_fmac_f32 v37, v7, v62
    v_lshlrev_b32 v6, 16, v107
    v_and_b32 v7, 0xffff0000, v107
    v_fmac_f32 v30, v6, v50
    v_fmac_f32 v31, v7, v50
    v_fmac_f32 v38, v6, v62
    v_fmac_f32 v39, v7, v62
    s_add_u32 s54, s52, 4456448
    buffer_load_dwordx4 v[104:107], v3, s[44:47], s54 offen
    v_lshlrev_b32 v6, 16, v108
    v_and_b32 v7, 0xffff0000, v108
    v_fmac_f32 v24, v6, v51
    v_fmac_f32 v25, v7, v51
    v_fmac_f32 v32, v6, v63
    v_fmac_f32 v33, v7, v63
    v_lshlrev_b32 v6, 16, v109
    v_and_b32 v7, 0xffff0000, v109
    v_fmac_f32 v26, v6, v51
    v_fmac_f32 v27, v7, v51
    v_fmac_f32 v34, v6, v63
    v_fmac_f32 v35, v7, v63
    v_lshlrev_b32 v6, 16, v110
    v_and_b32 v7, 0xffff0000, v110
    v_fmac_f32 v28, v6, v51
    v_fmac_f32 v29, v7, v51
    v_fmac_f32 v36, v6, v63
    v_fmac_f32 v37, v7, v63
    v_lshlrev_b32 v6, 16, v111
    v_and_b32 v7, 0xffff0000, v111
    v_fmac_f32 v30, v6, v51
    v_fmac_f32 v31, v7, v51
    v_fmac_f32 v38, v6, v63
    v_fmac_f32 v39, v7, v63
    s_add_u32 s54, s52, 4587520
    buffer_load_dwordx4 v[108:111], v3, s[44:47], s54 offen
    ds_read_b32 v40, v5 offset:26112
    ds_read_b32 v52, v5 offset:28416
    ds_read_b32 v41, v5 offset:26176
    ds_read_b32 v53, v5 offset:28480
    ds_read_b32 v42, v5 offset:26240
    ds_read_b32 v54, v5 offset:28544
    ds_read_b32 v43, v5 offset:26304
    ds_read_b32 v55, v5 offset:28608
    ds_read_b32 v44, v5 offset:26368
    ds_read_b32 v56, v5 offset:28672
    ds_read_b32 v45, v5 offset:26432
    ds_read_b32 v57, v5 offset:28736
    ds_read_b32 v46, v5 offset:26496
    ds_read_b32 v58, v5 offset:28800
    ds_read_b32 v47, v5 offset:26560
    ds_read_b32 v59, v5 offset:28864
    ds_read_b32 v48, v5 offset:26624
    ds_read_b32 v60, v5 offset:28928
    ds_read_b32 v49, v5 offset:26688
    ds_read_b32 v61, v5 offset:28992
    ds_read_b32 v50, v5 offset:26752
    ds_read_b32 v62, v5 offset:29056
    ds_read_b32 v51, v5 offset:26816
    ds_read_b32 v63, v5 offset:29120
    s_waitcnt vmcnt(0) lgkmcnt(0)
    v_lshlrev_b32 v6, 16, v64
    v_and_b32 v7, 0xffff0000, v64
    v_fmac_f32 v24, v6, v40
    v_fmac_f32 v25, v7, v40
    v_fmac_f32 v32, v6, v52
    v_fmac_f32 v33, v7, v52
    v_lshlrev_b32 v6, 16, v65
    v_and_b32 v7, 0xffff0000, v65
    v_fmac_f32 v26, v6, v40
    v_fmac_f32 v27, v7, v40
    v_fmac_f32 v34, v6, v52
    v_fmac_f32 v35, v7, v52
    v_lshlrev_b32 v6, 16, v66
    v_and_b32 v7, 0xffff0000, v66
    v_fmac_f32 v28, v6, v40
    v_fmac_f32 v29, v7, v40
    v_fmac_f32 v36, v6, v52
    v_fmac_f32 v37, v7, v52
    v_lshlrev_b32 v6, 16, v67
    v_and_b32 v7, 0xffff0000, v67
    v_fmac_f32 v30, v6, v40
    v_fmac_f32 v31, v7, v40
    v_fmac_f32 v38, v6, v52
    v_fmac_f32 v39, v7, v52
    v_lshlrev_b32 v6, 16, v68
    v_and_b32 v7, 0xffff0000, v68
    v_fmac_f32 v24, v6, v41
    v_fmac_f32 v25, v7, v41
    v_fmac_f32 v32, v6, v53
    v_fmac_f32 v33, v7, v53
    v_lshlrev_b32 v6, 16, v69
    v_and_b32 v7, 0xffff0000, v69
    v_fmac_f32 v26, v6, v41
    v_fmac_f32 v27, v7, v41
    v_fmac_f32 v34, v6, v53
    v_fmac_f32 v35, v7, v53
    v_lshlrev_b32 v6, 16, v70
    v_and_b32 v7, 0xffff0000, v70
    v_fmac_f32 v28, v6, v41
    v_fmac_f32 v29, v7, v41
    v_fmac_f32 v36, v6, v53
    v_fmac_f32 v37, v7, v53
    v_lshlrev_b32 v6, 16, v71
    v_and_b32 v7, 0xffff0000, v71
    v_fmac_f32 v30, v6, v41
    v_fmac_f32 v31, v7, v41
    v_fmac_f32 v38, v6, v53
    v_fmac_f32 v39, v7, v53
    v_lshlrev_b32 v6, 16, v72
    v_and_b32 v7, 0xffff0000, v72
    v_fmac_f32 v24, v6, v42
    v_fmac_f32 v25, v7, v42
    v_fmac_f32 v32, v6, v54
    v_fmac_f32 v33, v7, v54
    v_lshlrev_b32 v6, 16, v73
    v_and_b32 v7, 0xffff0000, v73
    v_fmac_f32 v26, v6, v42
    v_fmac_f32 v27, v7, v42
    v_fmac_f32 v34, v6, v54
    v_fmac_f32 v35, v7, v54
    v_lshlrev_b32 v6, 16, v74
    v_and_b32 v7, 0xffff0000, v74
    v_fmac_f32 v28, v6, v42
    v_fmac_f32 v29, v7, v42
    v_fmac_f32 v36, v6, v54
    v_fmac_f32 v37, v7, v54
    v_lshlrev_b32 v6, 16, v75
    v_and_b32 v7, 0xffff0000, v75
    v_fmac_f32 v30, v6, v42
    v_fmac_f32 v31, v7, v42
    v_fmac_f32 v38, v6, v54
    v_fmac_f32 v39, v7, v54
    v_lshlrev_b32 v6, 16, v76
    v_and_b32 v7, 0xffff0000, v76
    v_fmac_f32 v24, v6, v43
    v_fmac_f32 v25, v7, v43
    v_fmac_f32 v32, v6, v55
    v_fmac_f32 v33, v7, v55
    v_lshlrev_b32 v6, 16, v77
    v_and_b32 v7, 0xffff0000, v77
    v_fmac_f32 v26, v6, v43
    v_fmac_f32 v27, v7, v43
    v_fmac_f32 v34, v6, v55
    v_fmac_f32 v35, v7, v55
    v_lshlrev_b32 v6, 16, v78
    v_and_b32 v7, 0xffff0000, v78
    v_fmac_f32 v28, v6, v43
    v_fmac_f32 v29, v7, v43
    v_fmac_f32 v36, v6, v55
    v_fmac_f32 v37, v7, v55
    v_lshlrev_b32 v6, 16, v79
    v_and_b32 v7, 0xffff0000, v79
    v_fmac_f32 v30, v6, v43
    v_fmac_f32 v31, v7, v43
    v_fmac_f32 v38, v6, v55
    v_fmac_f32 v39, v7, v55
    v_lshlrev_b32 v6, 16, v80
    v_and_b32 v7, 0xffff0000, v80
    v_fmac_f32 v24, v6, v44
    v_fmac_f32 v25, v7, v44
    v_fmac_f32 v32, v6, v56
    v_fmac_f32 v33, v7, v56
    v_lshlrev_b32 v6, 16, v81
    v_and_b32 v7, 0xffff0000, v81
    v_fmac_f32 v26, v6, v44
    v_fmac_f32 v27, v7, v44
    v_fmac_f32 v34, v6, v56
    v_fmac_f32 v35, v7, v56
    v_lshlrev_b32 v6, 16, v82
    v_and_b32 v7, 0xffff0000, v82
    v_fmac_f32 v28, v6, v44
    v_fmac_f32 v29, v7, v44
    v_fmac_f32 v36, v6, v56
    v_fmac_f32 v37, v7, v56
    v_lshlrev_b32 v6, 16, v83
    v_and_b32 v7, 0xffff0000, v83
    v_fmac_f32 v30, v6, v44
    v_fmac_f32 v31, v7, v44
    v_fmac_f32 v38, v6, v56
    v_fmac_f32 v39, v7, v56
    v_lshlrev_b32 v6, 16, v84
    v_and_b32 v7, 0xffff0000, v84
    v_fmac_f32 v24, v6, v45
    v_fmac_f32 v25, v7, v45
    v_fmac_f32 v32, v6, v57
    v_fmac_f32 v33, v7, v57
    v_lshlrev_b32 v6, 16, v85
    v_and_b32 v7, 0xffff0000, v85
    v_fmac_f32 v26, v6, v45
    v_fmac_f32 v27, v7, v45
    v_fmac_f32 v34, v6, v57
    v_fmac_f32 v35, v7, v57
    v_lshlrev_b32 v6, 16, v86
    v_and_b32 v7, 0xffff0000, v86
    v_fmac_f32 v28, v6, v45
    v_fmac_f32 v29, v7, v45
    v_fmac_f32 v36, v6, v57
    v_fmac_f32 v37, v7, v57
    v_lshlrev_b32 v6, 16, v87
    v_and_b32 v7, 0xffff0000, v87
    v_fmac_f32 v30, v6, v45
    v_fmac_f32 v31, v7, v45
    v_fmac_f32 v38, v6, v57
    v_fmac_f32 v39, v7, v57
    v_lshlrev_b32 v6, 16, v88
    v_and_b32 v7, 0xffff0000, v88
    v_fmac_f32 v24, v6, v46
    v_fmac_f32 v25, v7, v46
    v_fmac_f32 v32, v6, v58
    v_fmac_f32 v33, v7, v58
    v_lshlrev_b32 v6, 16, v89
    v_and_b32 v7, 0xffff0000, v89
    v_fmac_f32 v26, v6, v46
    v_fmac_f32 v27, v7, v46
    v_fmac_f32 v34, v6, v58
    v_fmac_f32 v35, v7, v58
    v_lshlrev_b32 v6, 16, v90
    v_and_b32 v7, 0xffff0000, v90
    v_fmac_f32 v28, v6, v46
    v_fmac_f32 v29, v7, v46
    v_fmac_f32 v36, v6, v58
    v_fmac_f32 v37, v7, v58
    v_lshlrev_b32 v6, 16, v91
    v_and_b32 v7, 0xffff0000, v91
    v_fmac_f32 v30, v6, v46
    v_fmac_f32 v31, v7, v46
    v_fmac_f32 v38, v6, v58
    v_fmac_f32 v39, v7, v58
    v_lshlrev_b32 v6, 16, v92
    v_and_b32 v7, 0xffff0000, v92
    v_fmac_f32 v24, v6, v47
    v_fmac_f32 v25, v7, v47
    v_fmac_f32 v32, v6, v59
    v_fmac_f32 v33, v7, v59
    v_lshlrev_b32 v6, 16, v93
    v_and_b32 v7, 0xffff0000, v93
    v_fmac_f32 v26, v6, v47
    v_fmac_f32 v27, v7, v47
    v_fmac_f32 v34, v6, v59
    v_fmac_f32 v35, v7, v59
    v_lshlrev_b32 v6, 16, v94
    v_and_b32 v7, 0xffff0000, v94
    v_fmac_f32 v28, v6, v47
    v_fmac_f32 v29, v7, v47
    v_fmac_f32 v36, v6, v59
    v_fmac_f32 v37, v7, v59
    v_lshlrev_b32 v6, 16, v95
    v_and_b32 v7, 0xffff0000, v95
    v_fmac_f32 v30, v6, v47
    v_fmac_f32 v31, v7, v47
    v_fmac_f32 v38, v6, v59
    v_fmac_f32 v39, v7, v59
    v_lshlrev_b32 v6, 16, v96
    v_and_b32 v7, 0xffff0000, v96
    v_fmac_f32 v24, v6, v48
    v_fmac_f32 v25, v7, v48
    v_fmac_f32 v32, v6, v60
    v_fmac_f32 v33, v7, v60
    v_lshlrev_b32 v6, 16, v97
    v_and_b32 v7, 0xffff0000, v97
    v_fmac_f32 v26, v6, v48
    v_fmac_f32 v27, v7, v48
    v_fmac_f32 v34, v6, v60
    v_fmac_f32 v35, v7, v60
    v_lshlrev_b32 v6, 16, v98
    v_and_b32 v7, 0xffff0000, v98
    v_fmac_f32 v28, v6, v48
    v_fmac_f32 v29, v7, v48
    v_fmac_f32 v36, v6, v60
    v_fmac_f32 v37, v7, v60
    v_lshlrev_b32 v6, 16, v99
    v_and_b32 v7, 0xffff0000, v99
    v_fmac_f32 v30, v6, v48
    v_fmac_f32 v31, v7, v48
    v_fmac_f32 v38, v6, v60
    v_fmac_f32 v39, v7, v60
    v_lshlrev_b32 v6, 16, v100
    v_and_b32 v7, 0xffff0000, v100
    v_fmac_f32 v24, v6, v49
    v_fmac_f32 v25, v7, v49
    v_fmac_f32 v32, v6, v61
    v_fmac_f32 v33, v7, v61
    v_lshlrev_b32 v6, 16, v101
    v_and_b32 v7, 0xffff0000, v101
    v_fmac_f32 v26, v6, v49
    v_fmac_f32 v27, v7, v49
    v_fmac_f32 v34, v6, v61
    v_fmac_f32 v35, v7, v61
    v_lshlrev_b32 v6, 16, v102
    v_and_b32 v7, 0xffff0000, v102
    v_fmac_f32 v28, v6, v49
    v_fmac_f32 v29, v7, v49
    v_fmac_f32 v36, v6, v61
    v_fmac_f32 v37, v7, v61
    v_lshlrev_b32 v6, 16, v103
    v_and_b32 v7, 0xffff0000, v103
    v_fmac_f32 v30, v6, v49
    v_fmac_f32 v31, v7, v49
    v_fmac_f32 v38, v6, v61
    v_fmac_f32 v39, v7, v61
    v_lshlrev_b32 v6, 16, v104
    v_and_b32 v7, 0xffff0000, v104
    v_fmac_f32 v24, v6, v50
    v_fmac_f32 v25, v7, v50
    v_fmac_f32 v32, v6, v62
    v_fmac_f32 v33, v7, v62
    v_lshlrev_b32 v6, 16, v105
    v_and_b32 v7, 0xffff0000, v105
    v_fmac_f32 v26, v6, v50
    v_fmac_f32 v27, v7, v50
    v_fmac_f32 v34, v6, v62
    v_fmac_f32 v35, v7, v62
    v_lshlrev_b32 v6, 16, v106
    v_and_b32 v7, 0xffff0000, v106
    v_fmac_f32 v28, v6, v50
    v_fmac_f32 v29, v7, v50
    v_fmac_f32 v36, v6, v62
    v_fmac_f32 v37, v7, v62
    v_lshlrev_b32 v6, 16, v107
    v_and_b32 v7, 0xffff0000, v107
    v_fmac_f32 v30, v6, v50
    v_fmac_f32 v31, v7, v50
    v_fmac_f32 v38, v6, v62
    v_fmac_f32 v39, v7, v62
    v_lshlrev_b32 v6, 16, v108
    v_and_b32 v7, 0xffff0000, v108
    v_fmac_f32 v24, v6, v51
    v_fmac_f32 v25, v7, v51
    v_fmac_f32 v32, v6, v63
    v_fmac_f32 v33, v7, v63
    v_lshlrev_b32 v6, 16, v109
    v_and_b32 v7, 0xffff0000, v109
    v_fmac_f32 v26, v6, v51
    v_fmac_f32 v27, v7, v51
    v_fmac_f32 v34, v6, v63
    v_fmac_f32 v35, v7, v63
    v_lshlrev_b32 v6, 16, v110
    v_and_b32 v7, 0xffff0000, v110
    v_fmac_f32 v28, v6, v51
    v_fmac_f32 v29, v7, v51
    v_fmac_f32 v36, v6, v63
    v_fmac_f32 v37, v7, v63
    v_lshlrev_b32 v6, 16, v111
    v_and_b32 v7, 0xffff0000, v111
    v_fmac_f32 v30, v6, v51
    v_fmac_f32 v31, v7, v51
    v_fmac_f32 v38, v6, v63
    v_fmac_f32 v39, v7, v63
    v_lshlrev_b32 v7, 10, v2
    v_lshl_add_u32 v7, v1, 5, v7
    ds_write_b128 v7, v[24:27] offset:8192
    ds_write_b128 v7, v[28:31] offset:8208
    ds_write_b128 v7, v[32:35] offset:8704
    ds_write_b128 v7, v[36:39] offset:8720
    s_waitcnt lgkmcnt(0)
    v_mov_b32 v120, 100
    v_mov_b32 v121, 1
    s_mov_b64 exec, 1
    ds_add_u32 v120, v121
    s_mov_b64 exec, -1
SB_30:
    ds_read_b32 v121, v120
    s_waitcnt lgkmcnt(0)
    v_readfirstlane_b32 s90, v121
    s_cmp_ge_u32 s90, 4
    s_cbranch_scc1 SB_30d
    s_sleep 1
    s_branch SB_30
SB_30d:
    v_lshlrev_b32 v7, 2, v0
    ds_read_b32 v8, v7 offset:8192
    ds_read_b32 v9, v7 offset:9216
    ds_read_b32 v10, v7 offset:10240
    ds_read_b32 v11, v7 offset:11264
    ds_read_b32 v12, v7 offset:12288
    ds_read_b32 v13, v7 offset:13312
    ds_read_b32 v14, v7 offset:14336
    ds_read_b32 v15, v7 offset:15360
    ds_read_b32 v16, v7 offset:16384
    ds_read_b32 v17, v7 offset:17408
    ds_read_b32 v18, v7 offset:18432
    ds_read_b32 v19, v7 offset:19456
    ds_read_b32 v20, v7 offset:20480
    ds_read_b32 v21, v7 offset:21504
    ds_read_b32 v22, v7 offset:22528
    ds_read_b32 v23, v7 offset:23552
    s_waitcnt lgkmcnt(0)
    v_add_f32 v8, v8, v16
    v_add_f32 v9, v9, v17
    v_add_f32 v10, v10, v18
    v_add_f32 v11, v11, v19
    v_add_f32 v12, v12, v20
    v_add_f32 v13, v13, v21
    v_add_f32 v14, v14, v22
    v_add_f32 v15, v15, v23
    v_add_f32 v8, v8, v12
    v_add_f32 v9, v9, v13
    v_add_f32 v10, v10, v14
    v_add_f32 v11, v11, v15
    v_add_f32 v8, v8, v10
    v_add_f32 v9, v9, v11
    v_add_f32 v8, v8, v9
    v_cvt_pk_bf16_f32 v8, v8, v8
    v_lshlrev_b32 v8, 16, v8
    ds_write_b32 v7, v8 offset:29184
    s_waitcnt lgkmcnt(0)
    v_mov_b32 v120, 104
    v_mov_b32 v121, 1
    s_mov_b64 exec, 1
    ds_add_u32 v120, v121
    s_mov_b64 exec, -1
SB_31:
    ds_read_b32 v121, v120
    s_waitcnt lgkmcnt(0)
    v_readfirstlane_b32 s90, v121
    s_cmp_ge_u32 s90, 4
    s_cbranch_scc1 SB_31d
    s_sleep 1
    s_branch SB_31
SB_31d:
    v_lshlrev_b32 v4, 5, v1
    ds_read_b128 v[16:19], v4 offset:29184
    ds_read_b128 v[20:23], v4 offset:29200
    ds_read_b128 v[24:27], v4 offset:29696
    ds_read_b128 v[28:31], v4 offset:29712
    v_accvgpr_read_b32 v80, a64
    v_accvgpr_read_b32 v81, a65
    v_accvgpr_read_b32 v82, a66
    v_accvgpr_read_b32 v83, a67
    v_accvgpr_read_b32 v84, a68
    v_accvgpr_read_b32 v85, a69
    v_accvgpr_read_b32 v86, a70
    v_accvgpr_read_b32 v87, a71
    v_accvgpr_read_b32 v88, a72
    v_accvgpr_read_b32 v89, a73
    v_accvgpr_read_b32 v90, a74
    v_accvgpr_read_b32 v91, a75
    v_accvgpr_read_b32 v92, a76
    v_accvgpr_read_b32 v93, a77
    v_accvgpr_read_b32 v94, a78
    v_accvgpr_read_b32 v95, a79
    v_accvgpr_read_b32 v96, a80
    v_accvgpr_read_b32 v97, a81
    v_accvgpr_read_b32 v98, a82
    v_accvgpr_read_b32 v99, a83
    v_accvgpr_read_b32 v100, a84
    v_accvgpr_read_b32 v101, a85
    v_accvgpr_read_b32 v102, a86
    v_accvgpr_read_b32 v103, a87
    v_accvgpr_read_b32 v104, a88
    v_accvgpr_read_b32 v105, a89
    v_accvgpr_read_b32 v106, a90
    v_accvgpr_read_b32 v107, a91
    v_accvgpr_read_b32 v108, a92
    v_accvgpr_read_b32 v109, a93
    v_accvgpr_read_b32 v110, a94
    v_accvgpr_read_b32 v111, a95
    s_waitcnt lgkmcnt(0)
    v_lshlrev_b32 v6, 16, v80
    v_and_b32 v7, 0xffff0000, v80
    v_mul_f32 v64, v6, v16
    v_mul_f32 v65, v6, v24
    v_fmac_f32 v64, v7, v17
    v_fmac_f32 v65, v7, v25
    v_lshlrev_b32 v6, 16, v81
    v_and_b32 v7, 0xffff0000, v81
    v_fmac_f32 v64, v6, v18
    v_fmac_f32 v65, v6, v26
    v_fmac_f32 v64, v7, v19
    v_fmac_f32 v65, v7, v27
    v_lshlrev_b32 v6, 16, v82
    v_and_b32 v7, 0xffff0000, v82
    v_fmac_f32 v64, v6, v20
    v_fmac_f32 v65, v6, v28
    v_fmac_f32 v64, v7, v21
    v_fmac_f32 v65, v7, v29
    v_lshlrev_b32 v6, 16, v83
    v_and_b32 v7, 0xffff0000, v83
    v_fmac_f32 v64, v6, v22
    v_fmac_f32 v65, v6, v30
    v_fmac_f32 v64, v7, v23
    v_fmac_f32 v65, v7, v31
    v_lshlrev_b32 v6, 16, v84
    v_and_b32 v7, 0xffff0000, v84
    v_mul_f32 v66, v6, v16
    v_mul_f32 v67, v6, v24
    v_fmac_f32 v66, v7, v17
    v_fmac_f32 v67, v7, v25
    v_lshlrev_b32 v6, 16, v85
    v_and_b32 v7, 0xffff0000, v85
    v_fmac_f32 v66, v6, v18
    v_fmac_f32 v67, v6, v26
    v_fmac_f32 v66, v7, v19
    v_fmac_f32 v67, v7, v27
    v_lshlrev_b32 v6, 16, v86
    v_and_b32 v7, 0xffff0000, v86
    v_fmac_f32 v66, v6, v20
    v_fmac_f32 v67, v6, v28
    v_fmac_f32 v66, v7, v21
    v_fmac_f32 v67, v7, v29
    v_lshlrev_b32 v6, 16, v87
    v_and_b32 v7, 0xffff0000, v87
    v_fmac_f32 v66, v6, v22
    v_fmac_f32 v67, v6, v30
    v_fmac_f32 v66, v7, v23
    v_fmac_f32 v67, v7, v31
    v_lshlrev_b32 v6, 16, v88
    v_and_b32 v7, 0xffff0000, v88
    v_mul_f32 v68, v6, v16
    v_mul_f32 v69, v6, v24
    v_fmac_f32 v68, v7, v17
    v_fmac_f32 v69, v7, v25
    v_lshlrev_b32 v6, 16, v89
    v_and_b32 v7, 0xffff0000, v89
    v_fmac_f32 v68, v6, v18
    v_fmac_f32 v69, v6, v26
    v_fmac_f32 v68, v7, v19
    v_fmac_f32 v69, v7, v27
    v_lshlrev_b32 v6, 16, v90
    v_and_b32 v7, 0xffff0000, v90
    v_fmac_f32 v68, v6, v20
    v_fmac_f32 v69, v6, v28
    v_fmac_f32 v68, v7, v21
    v_fmac_f32 v69, v7, v29
    v_lshlrev_b32 v6, 16, v91
    v_and_b32 v7, 0xffff0000, v91
    v_fmac_f32 v68, v6, v22
    v_fmac_f32 v69, v6, v30
    v_fmac_f32 v68, v7, v23
    v_fmac_f32 v69, v7, v31
    v_lshlrev_b32 v6, 16, v92
    v_and_b32 v7, 0xffff0000, v92
    v_mul_f32 v70, v6, v16
    v_mul_f32 v71, v6, v24
    v_fmac_f32 v70, v7, v17
    v_fmac_f32 v71, v7, v25
    v_lshlrev_b32 v6, 16, v93
    v_and_b32 v7, 0xffff0000, v93
    v_fmac_f32 v70, v6, v18
    v_fmac_f32 v71, v6, v26
    v_fmac_f32 v70, v7, v19
    v_fmac_f32 v71, v7, v27
    v_lshlrev_b32 v6, 16, v94
    v_and_b32 v7, 0xffff0000, v94
    v_fmac_f32 v70, v6, v20
    v_fmac_f32 v71, v6, v28
    v_fmac_f32 v70, v7, v21
    v_fmac_f32 v71, v7, v29
    v_lshlrev_b32 v6, 16, v95
    v_and_b32 v7, 0xffff0000, v95
    v_fmac_f32 v70, v6, v22
    v_fmac_f32 v71, v6, v30
    v_fmac_f32 v70, v7, v23
    v_fmac_f32 v71, v7, v31
    v_lshlrev_b32 v6, 16, v96
    v_and_b32 v7, 0xffff0000, v96
    v_mul_f32 v72, v6, v16
    v_mul_f32 v73, v6, v24
    v_fmac_f32 v72, v7, v17
    v_fmac_f32 v73, v7, v25
    v_lshlrev_b32 v6, 16, v97
    v_and_b32 v7, 0xffff0000, v97
    v_fmac_f32 v72, v6, v18
    v_fmac_f32 v73, v6, v26
    v_fmac_f32 v72, v7, v19
    v_fmac_f32 v73, v7, v27
    v_lshlrev_b32 v6, 16, v98
    v_and_b32 v7, 0xffff0000, v98
    v_fmac_f32 v72, v6, v20
    v_fmac_f32 v73, v6, v28
    v_fmac_f32 v72, v7, v21
    v_fmac_f32 v73, v7, v29
    v_lshlrev_b32 v6, 16, v99
    v_and_b32 v7, 0xffff0000, v99
    v_fmac_f32 v72, v6, v22
    v_fmac_f32 v73, v6, v30
    v_fmac_f32 v72, v7, v23
    v_fmac_f32 v73, v7, v31
    v_lshlrev_b32 v6, 16, v100
    v_and_b32 v7, 0xffff0000, v100
    v_mul_f32 v74, v6, v16
    v_mul_f32 v75, v6, v24
    v_fmac_f32 v74, v7, v17
    v_fmac_f32 v75, v7, v25
    v_lshlrev_b32 v6, 16, v101
    v_and_b32 v7, 0xffff0000, v101
    v_fmac_f32 v74, v6, v18
    v_fmac_f32 v75, v6, v26
    v_fmac_f32 v74, v7, v19
    v_fmac_f32 v75, v7, v27
    v_lshlrev_b32 v6, 16, v102
    v_and_b32 v7, 0xffff0000, v102
    v_fmac_f32 v74, v6, v20
    v_fmac_f32 v75, v6, v28
    v_fmac_f32 v74, v7, v21
    v_fmac_f32 v75, v7, v29
    v_lshlrev_b32 v6, 16, v103
    v_and_b32 v7, 0xffff0000, v103
    v_fmac_f32 v74, v6, v22
    v_fmac_f32 v75, v6, v30
    v_fmac_f32 v74, v7, v23
    v_fmac_f32 v75, v7, v31
    v_lshlrev_b32 v6, 16, v104
    v_and_b32 v7, 0xffff0000, v104
    v_mul_f32 v76, v6, v16
    v_mul_f32 v77, v6, v24
    v_fmac_f32 v76, v7, v17
    v_fmac_f32 v77, v7, v25
    v_lshlrev_b32 v6, 16, v105
    v_and_b32 v7, 0xffff0000, v105
    v_fmac_f32 v76, v6, v18
    v_fmac_f32 v77, v6, v26
    v_fmac_f32 v76, v7, v19
    v_fmac_f32 v77, v7, v27
    v_lshlrev_b32 v6, 16, v106
    v_and_b32 v7, 0xffff0000, v106
    v_fmac_f32 v76, v6, v20
    v_fmac_f32 v77, v6, v28
    v_fmac_f32 v76, v7, v21
    v_fmac_f32 v77, v7, v29
    v_lshlrev_b32 v6, 16, v107
    v_and_b32 v7, 0xffff0000, v107
    v_fmac_f32 v76, v6, v22
    v_fmac_f32 v77, v6, v30
    v_fmac_f32 v76, v7, v23
    v_fmac_f32 v77, v7, v31
    v_lshlrev_b32 v6, 16, v108
    v_and_b32 v7, 0xffff0000, v108
    v_mul_f32 v78, v6, v16
    v_mul_f32 v79, v6, v24
    v_fmac_f32 v78, v7, v17
    v_fmac_f32 v79, v7, v25
    v_lshlrev_b32 v6, 16, v109
    v_and_b32 v7, 0xffff0000, v109
    v_fmac_f32 v78, v6, v18
    v_fmac_f32 v79, v6, v26
    v_fmac_f32 v78, v7, v19
    v_fmac_f32 v79, v7, v27
    v_lshlrev_b32 v6, 16, v110
    v_and_b32 v7, 0xffff0000, v110
    v_fmac_f32 v78, v6, v20
    v_fmac_f32 v79, v6, v28
    v_fmac_f32 v78, v7, v21
    v_fmac_f32 v79, v7, v29
    v_lshlrev_b32 v6, 16, v111
    v_and_b32 v7, 0xffff0000, v111
    v_fmac_f32 v78, v6, v22
    v_fmac_f32 v79, v6, v30
    v_fmac_f32 v78, v7, v23
    v_fmac_f32 v79, v7, v31
    s_nop 1
    v_add_f32_dpp v64, v64, v64 row_shr:1 row_mask:0xf bank_mask:0xf bound_ctrl:0
    v_add_f32_dpp v65, v65, v65 row_shr:1 row_mask:0xf bank_mask:0xf bound_ctrl:0
    v_add_f32_dpp v66, v66, v66 row_shr:1 row_mask:0xf bank_mask:0xf bound_ctrl:0
    v_add_f32_dpp v67, v67, v67 row_shr:1 row_mask:0xf bank_mask:0xf bound_ctrl:0
    v_add_f32_dpp v68, v68, v68 row_shr:1 row_mask:0xf bank_mask:0xf bound_ctrl:0
    v_add_f32_dpp v69, v69, v69 row_shr:1 row_mask:0xf bank_mask:0xf bound_ctrl:0
    v_add_f32_dpp v70, v70, v70 row_shr:1 row_mask:0xf bank_mask:0xf bound_ctrl:0
    v_add_f32_dpp v71, v71, v71 row_shr:1 row_mask:0xf bank_mask:0xf bound_ctrl:0
    v_add_f32_dpp v72, v72, v72 row_shr:1 row_mask:0xf bank_mask:0xf bound_ctrl:0
    v_add_f32_dpp v73, v73, v73 row_shr:1 row_mask:0xf bank_mask:0xf bound_ctrl:0
    v_add_f32_dpp v74, v74, v74 row_shr:1 row_mask:0xf bank_mask:0xf bound_ctrl:0
    v_add_f32_dpp v75, v75, v75 row_shr:1 row_mask:0xf bank_mask:0xf bound_ctrl:0
    v_add_f32_dpp v76, v76, v76 row_shr:1 row_mask:0xf bank_mask:0xf bound_ctrl:0
    v_add_f32_dpp v77, v77, v77 row_shr:1 row_mask:0xf bank_mask:0xf bound_ctrl:0
    v_add_f32_dpp v78, v78, v78 row_shr:1 row_mask:0xf bank_mask:0xf bound_ctrl:0
    v_add_f32_dpp v79, v79, v79 row_shr:1 row_mask:0xf bank_mask:0xf bound_ctrl:0
    v_add_f32_dpp v64, v64, v64 row_shr:2 row_mask:0xf bank_mask:0xf bound_ctrl:0
    v_add_f32_dpp v65, v65, v65 row_shr:2 row_mask:0xf bank_mask:0xf bound_ctrl:0
    v_add_f32_dpp v66, v66, v66 row_shr:2 row_mask:0xf bank_mask:0xf bound_ctrl:0
    v_add_f32_dpp v67, v67, v67 row_shr:2 row_mask:0xf bank_mask:0xf bound_ctrl:0
    v_add_f32_dpp v68, v68, v68 row_shr:2 row_mask:0xf bank_mask:0xf bound_ctrl:0
    v_add_f32_dpp v69, v69, v69 row_shr:2 row_mask:0xf bank_mask:0xf bound_ctrl:0
    v_add_f32_dpp v70, v70, v70 row_shr:2 row_mask:0xf bank_mask:0xf bound_ctrl:0
    v_add_f32_dpp v71, v71, v71 row_shr:2 row_mask:0xf bank_mask:0xf bound_ctrl:0
    v_add_f32_dpp v72, v72, v72 row_shr:2 row_mask:0xf bank_mask:0xf bound_ctrl:0
    v_add_f32_dpp v73, v73, v73 row_shr:2 row_mask:0xf bank_mask:0xf bound_ctrl:0
    v_add_f32_dpp v74, v74, v74 row_shr:2 row_mask:0xf bank_mask:0xf bound_ctrl:0
    v_add_f32_dpp v75, v75, v75 row_shr:2 row_mask:0xf bank_mask:0xf bound_ctrl:0
    v_add_f32_dpp v76, v76, v76 row_shr:2 row_mask:0xf bank_mask:0xf bound_ctrl:0
    v_add_f32_dpp v77, v77, v77 row_shr:2 row_mask:0xf bank_mask:0xf bound_ctrl:0
    v_add_f32_dpp v78, v78, v78 row_shr:2 row_mask:0xf bank_mask:0xf bound_ctrl:0
    v_add_f32_dpp v79, v79, v79 row_shr:2 row_mask:0xf bank_mask:0xf bound_ctrl:0
    v_add_f32_dpp v64, v64, v64 row_shr:4 row_mask:0xf bank_mask:0xf bound_ctrl:0
    v_add_f32_dpp v65, v65, v65 row_shr:4 row_mask:0xf bank_mask:0xf bound_ctrl:0
    v_add_f32_dpp v66, v66, v66 row_shr:4 row_mask:0xf bank_mask:0xf bound_ctrl:0
    v_add_f32_dpp v67, v67, v67 row_shr:4 row_mask:0xf bank_mask:0xf bound_ctrl:0
    v_add_f32_dpp v68, v68, v68 row_shr:4 row_mask:0xf bank_mask:0xf bound_ctrl:0
    v_add_f32_dpp v69, v69, v69 row_shr:4 row_mask:0xf bank_mask:0xf bound_ctrl:0
    v_add_f32_dpp v70, v70, v70 row_shr:4 row_mask:0xf bank_mask:0xf bound_ctrl:0
    v_add_f32_dpp v71, v71, v71 row_shr:4 row_mask:0xf bank_mask:0xf bound_ctrl:0
    v_add_f32_dpp v72, v72, v72 row_shr:4 row_mask:0xf bank_mask:0xf bound_ctrl:0
    v_add_f32_dpp v73, v73, v73 row_shr:4 row_mask:0xf bank_mask:0xf bound_ctrl:0
    v_add_f32_dpp v74, v74, v74 row_shr:4 row_mask:0xf bank_mask:0xf bound_ctrl:0
    v_add_f32_dpp v75, v75, v75 row_shr:4 row_mask:0xf bank_mask:0xf bound_ctrl:0
    v_add_f32_dpp v76, v76, v76 row_shr:4 row_mask:0xf bank_mask:0xf bound_ctrl:0
    v_add_f32_dpp v77, v77, v77 row_shr:4 row_mask:0xf bank_mask:0xf bound_ctrl:0
    v_add_f32_dpp v78, v78, v78 row_shr:4 row_mask:0xf bank_mask:0xf bound_ctrl:0
    v_add_f32_dpp v79, v79, v79 row_shr:4 row_mask:0xf bank_mask:0xf bound_ctrl:0
    v_add_f32_dpp v64, v64, v64 row_shr:8 row_mask:0xf bank_mask:0xf bound_ctrl:0
    v_add_f32_dpp v65, v65, v65 row_shr:8 row_mask:0xf bank_mask:0xf bound_ctrl:0
    v_add_f32_dpp v66, v66, v66 row_shr:8 row_mask:0xf bank_mask:0xf bound_ctrl:0
    v_add_f32_dpp v67, v67, v67 row_shr:8 row_mask:0xf bank_mask:0xf bound_ctrl:0
    v_add_f32_dpp v68, v68, v68 row_shr:8 row_mask:0xf bank_mask:0xf bound_ctrl:0
    v_add_f32_dpp v69, v69, v69 row_shr:8 row_mask:0xf bank_mask:0xf bound_ctrl:0
    v_add_f32_dpp v70, v70, v70 row_shr:8 row_mask:0xf bank_mask:0xf bound_ctrl:0
    v_add_f32_dpp v71, v71, v71 row_shr:8 row_mask:0xf bank_mask:0xf bound_ctrl:0
    v_add_f32_dpp v72, v72, v72 row_shr:8 row_mask:0xf bank_mask:0xf bound_ctrl:0
    v_add_f32_dpp v73, v73, v73 row_shr:8 row_mask:0xf bank_mask:0xf bound_ctrl:0
    v_add_f32_dpp v74, v74, v74 row_shr:8 row_mask:0xf bank_mask:0xf bound_ctrl:0
    v_add_f32_dpp v75, v75, v75 row_shr:8 row_mask:0xf bank_mask:0xf bound_ctrl:0
    v_add_f32_dpp v76, v76, v76 row_shr:8 row_mask:0xf bank_mask:0xf bound_ctrl:0
    v_add_f32_dpp v77, v77, v77 row_shr:8 row_mask:0xf bank_mask:0xf bound_ctrl:0
    v_add_f32_dpp v78, v78, v78 row_shr:8 row_mask:0xf bank_mask:0xf bound_ctrl:0
    v_add_f32_dpp v79, v79, v79 row_shr:8 row_mask:0xf bank_mask:0xf bound_ctrl:0
    v_cmp_eq_u32 vcc, 15, v1
    s_and_saveexec_b64 s[56:57], vcc
    s_lshl_b32 s54, s61, 9
    s_lshl_b32 s55, s62, 7
    s_add_u32 s54, s54, s55
    v_add_u32 v3, s54, v2
    v_lshlrev_b32 v3, 1, v3
    v_cvt_pk_bf16_f32 v64, v64, v64
    v_cvt_pk_bf16_f32 v65, v65, v65
    s_mov_b32 s55, 32768
    buffer_store_short v64, v3, s[32:35], s55 offen sc1
    s_mov_b32 s55, 65536
    buffer_store_short v65, v3, s[32:35], s55 offen sc1
    v_cvt_pk_bf16_f32 v66, v66, v66
    v_cvt_pk_bf16_f32 v67, v67, v67
    s_mov_b32 s55, 32800
    buffer_store_short v66, v3, s[32:35], s55 offen sc1
    s_mov_b32 s55, 65568
    buffer_store_short v67, v3, s[32:35], s55 offen sc1
    v_cvt_pk_bf16_f32 v68, v68, v68
    v_cvt_pk_bf16_f32 v69, v69, v69
    s_mov_b32 s55, 32832
    buffer_store_short v68, v3, s[32:35], s55 offen sc1
    s_mov_b32 s55, 65600
    buffer_store_short v69, v3, s[32:35], s55 offen sc1
    v_cvt_pk_bf16_f32 v70, v70, v70
    v_cvt_pk_bf16_f32 v71, v71, v71
    s_mov_b32 s55, 32864
    buffer_store_short v70, v3, s[32:35], s55 offen sc1
    s_mov_b32 s55, 65632
    buffer_store_short v71, v3, s[32:35], s55 offen sc1
    v_cvt_pk_bf16_f32 v72, v72, v72
    v_cvt_pk_bf16_f32 v73, v73, v73
    s_mov_b32 s55, 32896
    buffer_store_short v72, v3, s[32:35], s55 offen sc1
    s_mov_b32 s55, 65664
    buffer_store_short v73, v3, s[32:35], s55 offen sc1
    v_cvt_pk_bf16_f32 v74, v74, v74
    v_cvt_pk_bf16_f32 v75, v75, v75
    s_mov_b32 s55, 32928
    buffer_store_short v74, v3, s[32:35], s55 offen sc1
    s_mov_b32 s55, 65696
    buffer_store_short v75, v3, s[32:35], s55 offen sc1
    v_cvt_pk_bf16_f32 v76, v76, v76
    v_cvt_pk_bf16_f32 v77, v77, v77
    s_mov_b32 s55, 32960
    buffer_store_short v76, v3, s[32:35], s55 offen sc1
    s_mov_b32 s55, 65728
    buffer_store_short v77, v3, s[32:35], s55 offen sc1
    v_cvt_pk_bf16_f32 v78, v78, v78
    v_cvt_pk_bf16_f32 v79, v79, v79
    s_mov_b32 s55, 32992
    buffer_store_short v78, v3, s[32:35], s55 offen sc1
    s_mov_b32 s55, 65760
    buffer_store_short v79, v3, s[32:35], s55 offen sc1
    s_mov_b64 exec, s[56:57]
    s_waitcnt vmcnt(0)
    s_waitcnt lgkmcnt(0)
    v_mov_b32 v120, 108
    v_mov_b32 v121, 1
    s_mov_b64 exec, 1
    ds_add_u32 v120, v121
    s_mov_b64 exec, -1
SB_32:
    ds_read_b32 v121, v120
    s_waitcnt lgkmcnt(0)
    v_readfirstlane_b32 s90, v121
    s_cmp_ge_u32 s90, 4
    s_cbranch_scc1 SB_32d
    s_sleep 1
    s_branch SB_32
SB_32d:
    s_cmp_lg_u32 s3, 0
    s_cbranch_scc1 L_qa_s
    s_lshl_b32 s54, s53, 2
    s_add_u32 s54, s54, 12591104
    v_mov_b32 v120, s54
    v_mov_b32 v121, s89
    s_mov_b64 exec, 1
    buffer_store_dword v121, v120, s[32:35], 0 offen sc1
    s_mov_b64 exec, -1
L_qa_s:
    v_and_b32 v56, 63, v0
    s_cmp_ge_u32 s2, 200
    s_cbranch_scc1 L_h_nopf2
    s_sub_u32 s63, s2, 128
    s_mov_b32 s84, s12
    s_mov_b32 s85, s13
    s_mov_b32 s86, 4718592
    s_mov_b32 s87, 0x00020000
    s_mul_i32 s65, s63, 7282
    s_lshr_b32 s65, s65, 16
    s_mul_i32 s64, s65, 9
    s_sub_u32 s64, s63, s64
    v_and_b32 v1, 7, v0
    v_lshrrev_b32 v2, 3, v0
    v_mul_u32_u24 v3, 1152, v2
    v_lshl_add_u32 v3, v1, 4, v3
    s_mul_i32 s55, s65, 589824
    s_lshl_b32 s54, s64, 7
    s_add_u32 s55, s55, s54
    s_add_u32 s54, s55, 0
    buffer_load_dwordx4 a[0:3], v3, s[84:87], s54 offen
    s_add_u32 s54, s55, 36864
    buffer_load_dwordx4 a[4:7], v3, s[84:87], s54 offen
    s_add_u32 s54, s55, 73728
    buffer_load_dwordx4 a[8:11], v3, s[84:87], s54 offen
    s_add_u32 s54, s55, 110592
    buffer_load_dwordx4 a[12:15], v3, s[84:87], s54 offen
    s_add_u32 s54, s55, 147456
    buffer_load_dwordx4 a[16:19], v3, s[84:87], s54 offen
    s_add_u32 s54, s55, 184320
    buffer_load_dwordx4 a[20:23], v3, s[84:87], s54 offen
    s_add_u32 s54, s55, 221184
    buffer_load_dwordx4 a[24:27], v3, s[84:87], s54 offen
    s_add_u32 s54, s55, 258048
    buffer_load_dwordx4 a[28:31], v3, s[84:87], s54 offen
    s_add_u32 s54, s55, 294912
    buffer_load_dwordx4 a[32:35], v3, s[84:87], s54 offen
    s_add_u32 s54, s55, 331776
    buffer_load_dwordx4 a[36:39], v3, s[84:87], s54 offen
    s_add_u32 s54, s55, 368640
    buffer_load_dwordx4 a[40:43], v3, s[84:87], s54 offen
    s_add_u32 s54, s55, 405504
    buffer_load_dwordx4 a[44:47], v3, s[84:87], s54 offen
    s_add_u32 s54, s55, 442368
    buffer_load_dwordx4 a[48:51], v3, s[84:87], s54 offen
    s_add_u32 s54, s55, 479232
    buffer_load_dwordx4 a[52:55], v3, s[84:87], s54 offen
    s_add_u32 s54, s55, 516096
    buffer_load_dwordx4 a[56:59], v3, s[84:87], s54 offen
    s_add_u32 s54, s55, 552960
    buffer_load_dwordx4 a[60:63], v3, s[84:87], s54 offen
L_h_nopf2:
    s_cmp_lg_u32 s3, 0
    s_cbranch_scc1 L_h_q2
    v_and_b32 v56, 63, v0
    s_bfe_u32 s54, s2, 0x40003
    s_lshl_b32 s55, s54, 7
    s_add_u32 s55, s55, 12582912
    v_cmp_gt_u32 vcc, 8, v56
    v_lshlrev_b32 v120, 2, v56
    s_nop 1
    v_cndmask_b32 v120, 0, v120, vcc
GP_33:
    buffer_load_dword v121, v120, s[32:35], s55 offen sc1
    s_waitcnt vmcnt(0)
    v_cmp_ne_u32 vcc, s89, v121
    s_cmp_eq_u64 vcc, 0
    s_cbranch_scc1 GP_33d
    s_sleep 16
    s_branch GP_33
GP_33d:
    s_lshr_b32 s55, s2, 7
    s_lshl_b32 s55, s55, 13
    s_lshl_b32 s54, s54, 9
    s_add_u32 s55, s55, s54
    v_lshlrev_b32 v1, 4, v56
    v_cmp_gt_u32 vcc, 32, v56
    s_and_saveexec_b64 s[56:57], vcc
    buffer_load_dwordx4 v[8:11], v1, s[32:35], s55 offen offset:0 sc1
    s_waitcnt vmcnt(0)
    ds_write_b128 v1, v[8:11] offset:256
    s_mov_b64 exec, s[56:57]
    s_waitcnt lgkmcnt(0)
    v_mov_b32 v120, 0
    v_mov_b32 v121, 1
    s_mov_b64 exec, 1
    ds_add_u32 v120, v121
    s_mov_b64 exec, -1
L_h_q2:
    s_cmp_ge_u32 s2, 200
    s_cbranch_scc1 L_end
    s_mov_b32 s48, s26
    s_mov_b32 s49, s27
    s_mov_b32 s50, 4608
    s_mov_b32 s51, 0x00020000
    v_and_b32 v1, 7, v0
    v_lshrrev_b32 v2, 3, v0
    s_cmp_lg_u32 s3, 0
    s_cbranch_scc1 L_opA_w
    s_lshl_b32 s54, s65, 7
    s_add_u32 s54, s54, 12595200
    v_cmp_gt_u32 vcc, 32, v56
    v_lshlrev_b32 v61, 2, v56
    s_nop 1
    v_cndmask_b32 v61, 0, v61, vcc
GP_34:
    buffer_load_dword v62, v61, s[32:35], s54 offen sc1
    s_waitcnt vmcnt(0)
    v_cmp_ne_u32 vcc, s89, v62
    s_cmp_eq_u64 vcc, 0
    s_cbranch_scc1 GP_34d
    s_sleep 16
    s_branch GP_34
GP_34d:
    s_waitcnt lgkmcnt(0)
    v_mov_b32 v61, 16
    v_mov_b32 v62, 1
    s_mov_b64 exec, 1
    ds_add_u32 v61, v62
    s_mov_b64 exec, -1
L_opA_w:
    v_mov_b32 v61, 16
LW_35:
    ds_read_b32 v62, v61
    s_waitcnt lgkmcnt(0)
    v_readfirstlane_b32 s90, v62
    s_cmp_ge_u32 s90, 1
    s_cbranch_scc1 LW_35d
    s_sleep 1
    s_branch LW_35
LW_35d:
    v_lshrrev_b32 v4, 7, v0
    v_and_b32 v5, 127, v0
    s_lshl_b32 s54, s65, 2
    v_add_u32 v6, s54, v4
    v_mul_u32_u24 v6, 4224, v6
    v_lshl_add_u32 v7, v5, 2, v6
    s_mov_b32 s55, 131072
    buffer_load_dwordx2 v[16:17], v6, s[32:35], s55 offen offset:512 sc1
    buffer_load_dword v32, v7, s[32:35], s55 offen sc1
    s_mov_b32 s55, 131600
    buffer_load_dwordx2 v[18:19], v6, s[32:35], s55 offen offset:512 sc1
    buffer_load_dword v33, v7, s[32:35], s55 offen sc1
    s_mov_b32 s55, 132128
    buffer_load_dwordx2 v[20:21], v6, s[32:35], s55 offen offset:512 sc1
    buffer_load_dword v34, v7, s[32:35], s55 offen sc1
    s_mov_b32 s55, 132656
    buffer_load_dwordx2 v[22:23], v6, s[32:35], s55 offen offset:512 sc1
    buffer_load_dword v35, v7, s[32:35], s55 offen sc1
    s_mov_b32 s55, 133184
    buffer_load_dwordx2 v[24:25], v6, s[32:35], s55 offen offset:512 sc1
    buffer_load_dword v36, v7, s[32:35], s55 offen sc1
    s_mov_b32 s55, 133712
    buffer_load_dwordx2 v[26:27], v6, s[32:35], s55 offen offset:512 sc1
    buffer_load_dword v37, v7, s[32:35], s55 offen sc1
    s_mov_b32 s55, 134240
    buffer_load_dwordx2 v[28:29], v6, s[32:35], s55 offen offset:512 sc1
    buffer_load_dword v38, v7, s[32:35], s55 offen sc1
    s_mov_b32 s55, 134768
    buffer_load_dwordx2 v[30:31], v6, s[32:35], s55 offen offset:512 sc1
    buffer_load_dword v39, v7, s[32:35], s55 offen sc1
    s_waitcnt vmcnt(0)
    v_max3_f32 v40, v16, v18, v20
    v_max3_f32 v40, v40, v22, v24
    v_max3_f32 v40, v40, v26, v28
    v_max_f32 v40, v40, v30
    v_sub_f32 v16, v16, v40
    v_sub_f32 v18, v18, v40
    v_sub_f32 v20, v20, v40
    v_sub_f32 v22, v22, v40
    v_sub_f32 v24, v24, v40
    v_sub_f32 v26, v26, v40
    v_sub_f32 v28, v28, v40
    v_sub_f32 v30, v30, v40
    v_exp_f32 v16, v16
    v_exp_f32 v18, v18
    v_exp_f32 v20, v20
    v_exp_f32 v22, v22
    v_exp_f32 v24, v24
    v_exp_f32 v26, v26
    v_exp_f32 v28, v28
    v_exp_f32 v30, v30
    s_nop 0
    v_mul_f32 v41, v16, v17
    v_mul_f32 v42, v16, v32
    v_fmac_f32 v41, v18, v19
    v_fmac_f32 v42, v18, v33
    v_fmac_f32 v41, v20, v21
    v_fmac_f32 v42, v20, v34
    v_fmac_f32 v41, v22, v23
    v_fmac_f32 v42, v22, v35
    v_fmac_f32 v41, v24, v25
    v_fmac_f32 v42, v24, v36
    v_fmac_f32 v41, v26, v27
    v_fmac_f32 v42, v26, v37
    v_fmac_f32 v41, v28, v29
    v_fmac_f32 v42, v28, v38
    v_fmac_f32 v41, v30, v31
    v_fmac_f32 v42, v30, v39
    v_rcp_f32 v41, v41
    s_nop 0
    v_mul_f32 v8, v42, v41
    s_mov_b32 s55, 266240
    buffer_load_dwordx2 v[16:17], v6, s[32:35], s55 offen offset:512 sc1
    buffer_load_dword v32, v7, s[32:35], s55 offen sc1
    s_mov_b32 s55, 266768
    buffer_load_dwordx2 v[18:19], v6, s[32:35], s55 offen offset:512 sc1
    buffer_load_dword v33, v7, s[32:35], s55 offen sc1
    s_mov_b32 s55, 267296
    buffer_load_dwordx2 v[20:21], v6, s[32:35], s55 offen offset:512 sc1
    buffer_load_dword v34, v7, s[32:35], s55 offen sc1
    s_mov_b32 s55, 267824
    buffer_load_dwordx2 v[22:23], v6, s[32:35], s55 offen offset:512 sc1
    buffer_load_dword v35, v7, s[32:35], s55 offen sc1
    s_mov_b32 s55, 268352
    buffer_load_dwordx2 v[24:25], v6, s[32:35], s55 offen offset:512 sc1
    buffer_load_dword v36, v7, s[32:35], s55 offen sc1
    s_mov_b32 s55, 268880
    buffer_load_dwordx2 v[26:27], v6, s[32:35], s55 offen offset:512 sc1
    buffer_load_dword v37, v7, s[32:35], s55 offen sc1
    s_mov_b32 s55, 269408
    buffer_load_dwordx2 v[28:29], v6, s[32:35], s55 offen offset:512 sc1
    buffer_load_dword v38, v7, s[32:35], s55 offen sc1
    s_mov_b32 s55, 269936
    buffer_load_dwordx2 v[30:31], v6, s[32:35], s55 offen offset:512 sc1
    buffer_load_dword v39, v7, s[32:35], s55 offen sc1
    s_waitcnt vmcnt(0)
    v_max3_f32 v40, v16, v18, v20
    v_max3_f32 v40, v40, v22, v24
    v_max3_f32 v40, v40, v26, v28
    v_max_f32 v40, v40, v30
    v_sub_f32 v16, v16, v40
    v_sub_f32 v18, v18, v40
    v_sub_f32 v20, v20, v40
    v_sub_f32 v22, v22, v40
    v_sub_f32 v24, v24, v40
    v_sub_f32 v26, v26, v40
    v_sub_f32 v28, v28, v40
    v_sub_f32 v30, v30, v40
    v_exp_f32 v16, v16
    v_exp_f32 v18, v18
    v_exp_f32 v20, v20
    v_exp_f32 v22, v22
    v_exp_f32 v24, v24
    v_exp_f32 v26, v26
    v_exp_f32 v28, v28
    v_exp_f32 v30, v30
    s_nop 0
    v_mul_f32 v41, v16, v17
    v_mul_f32 v42, v16, v32
    v_fmac_f32 v41, v18, v19
    v_fmac_f32 v42, v18, v33
    v_fmac_f32 v41, v20, v21
    v_fmac_f32 v42, v20, v34
    v_fmac_f32 v41, v22, v23
    v_fmac_f32 v42, v22, v35
    v_fmac_f32 v41, v24, v25
    v_fmac_f32 v42, v24, v36
    v_fmac_f32 v41, v26, v27
    v_fmac_f32 v42, v26, v37
    v_fmac_f32 v41, v28, v29
    v_fmac_f32 v42, v28, v38
    v_fmac_f32 v41, v30, v31
    v_fmac_f32 v42, v30, v39
    v_rcp_f32 v41, v41
    s_nop 0
    v_mul_f32 v9, v42, v41
    s_mov_b32 s55, 139520
    buffer_load_dwordx2 v[16:17], v6, s[32:35], s55 offen offset:512 sc1
    buffer_load_dword v32, v7, s[32:35], s55 offen sc1
    s_mov_b32 s55, 140048
    buffer_load_dwordx2 v[18:19], v6, s[32:35], s55 offen offset:512 sc1
    buffer_load_dword v33, v7, s[32:35], s55 offen sc1
    s_mov_b32 s55, 140576
    buffer_load_dwordx2 v[20:21], v6, s[32:35], s55 offen offset:512 sc1
    buffer_load_dword v34, v7, s[32:35], s55 offen sc1
    s_mov_b32 s55, 141104
    buffer_load_dwordx2 v[22:23], v6, s[32:35], s55 offen offset:512 sc1
    buffer_load_dword v35, v7, s[32:35], s55 offen sc1
    s_mov_b32 s55, 141632
    buffer_load_dwordx2 v[24:25], v6, s[32:35], s55 offen offset:512 sc1
    buffer_load_dword v36, v7, s[32:35], s55 offen sc1
    s_mov_b32 s55, 142160
    buffer_load_dwordx2 v[26:27], v6, s[32:35], s55 offen offset:512 sc1
    buffer_load_dword v37, v7, s[32:35], s55 offen sc1
    s_mov_b32 s55, 142688
    buffer_load_dwordx2 v[28:29], v6, s[32:35], s55 offen offset:512 sc1
    buffer_load_dword v38, v7, s[32:35], s55 offen sc1
    s_mov_b32 s55, 143216
    buffer_load_dwordx2 v[30:31], v6, s[32:35], s55 offen offset:512 sc1
    buffer_load_dword v39, v7, s[32:35], s55 offen sc1
    s_waitcnt vmcnt(0)
    v_max3_f32 v40, v16, v18, v20
    v_max3_f32 v40, v40, v22, v24
    v_max3_f32 v40, v40, v26, v28
    v_max_f32 v40, v40, v30
    v_sub_f32 v16, v16, v40
    v_sub_f32 v18, v18, v40
    v_sub_f32 v20, v20, v40
    v_sub_f32 v22, v22, v40
    v_sub_f32 v24, v24, v40
    v_sub_f32 v26, v26, v40
    v_sub_f32 v28, v28, v40
    v_sub_f32 v30, v30, v40
    v_exp_f32 v16, v16
    v_exp_f32 v18, v18
    v_exp_f32 v20, v20
    v_exp_f32 v22, v22
    v_exp_f32 v24, v24
    v_exp_f32 v26, v26
    v_exp_f32 v28, v28
    v_exp_f32 v30, v30
    s_nop 0
    v_mul_f32 v41, v16, v17
    v_mul_f32 v42, v16, v32
    v_fmac_f32 v41, v18, v19
    v_fmac_f32 v42, v18, v33
    v_fmac_f32 v41, v20, v21
    v_fmac_f32 v42, v20, v34
    v_fmac_f32 v41, v22, v23
    v_fmac_f32 v42, v22, v35
    v_fmac_f32 v41, v24, v25
    v_fmac_f32 v42, v24, v36
    v_fmac_f32 v41, v26, v27
    v_fmac_f32 v42, v26, v37
    v_fmac_f32 v41, v28, v29
    v_fmac_f32 v42, v28, v38
    v_fmac_f32 v41, v30, v31
    v_fmac_f32 v42, v30, v39
    v_rcp_f32 v41, v41
    s_nop 0
    v_mul_f32 v10, v42, v41
    s_mov_b32 s55, 274688
    buffer_load_dwordx2 v[16:17], v6, s[32:35], s55 offen offset:512 sc1
    buffer_load_dword v32, v7, s[32:35], s55 offen sc1
    s_mov_b32 s55, 275216
    buffer_load_dwordx2 v[18:19], v6, s[32:35], s55 offen offset:512 sc1
    buffer_load_dword v33, v7, s[32:35], s55 offen sc1
    s_mov_b32 s55, 275744
    buffer_load_dwordx2 v[20:21], v6, s[32:35], s55 offen offset:512 sc1
    buffer_load_dword v34, v7, s[32:35], s55 offen sc1
    s_mov_b32 s55, 276272
    buffer_load_dwordx2 v[22:23], v6, s[32:35], s55 offen offset:512 sc1
    buffer_load_dword v35, v7, s[32:35], s55 offen sc1
    s_mov_b32 s55, 276800
    buffer_load_dwordx2 v[24:25], v6, s[32:35], s55 offen offset:512 sc1
    buffer_load_dword v36, v7, s[32:35], s55 offen sc1
    s_mov_b32 s55, 277328
    buffer_load_dwordx2 v[26:27], v6, s[32:35], s55 offen offset:512 sc1
    buffer_load_dword v37, v7, s[32:35], s55 offen sc1
    s_mov_b32 s55, 277856
    buffer_load_dwordx2 v[28:29], v6, s[32:35], s55 offen offset:512 sc1
    buffer_load_dword v38, v7, s[32:35], s55 offen sc1
    s_mov_b32 s55, 278384
    buffer_load_dwordx2 v[30:31], v6, s[32:35], s55 offen offset:512 sc1
    buffer_load_dword v39, v7, s[32:35], s55 offen sc1
    s_waitcnt vmcnt(0)
    v_max3_f32 v40, v16, v18, v20
    v_max3_f32 v40, v40, v22, v24
    v_max3_f32 v40, v40, v26, v28
    v_max_f32 v40, v40, v30
    v_sub_f32 v16, v16, v40
    v_sub_f32 v18, v18, v40
    v_sub_f32 v20, v20, v40
    v_sub_f32 v22, v22, v40
    v_sub_f32 v24, v24, v40
    v_sub_f32 v26, v26, v40
    v_sub_f32 v28, v28, v40
    v_sub_f32 v30, v30, v40
    v_exp_f32 v16, v16
    v_exp_f32 v18, v18
    v_exp_f32 v20, v20
    v_exp_f32 v22, v22
    v_exp_f32 v24, v24
    v_exp_f32 v26, v26
    v_exp_f32 v28, v28
    v_exp_f32 v30, v30
    s_nop 0
    v_mul_f32 v41, v16, v17
    v_mul_f32 v42, v16, v32
    v_fmac_f32 v41, v18, v19
    v_fmac_f32 v42, v18, v33
    v_fmac_f32 v41, v20, v21
    v_fmac_f32 v42, v20, v34
    v_fmac_f32 v41, v22, v23
    v_fmac_f32 v42, v22, v35
    v_fmac_f32 v41, v24, v25
    v_fmac_f32 v42, v24, v36
    v_fmac_f32 v41, v26, v27
    v_fmac_f32 v42, v26, v37
    v_fmac_f32 v41, v28, v29
    v_fmac_f32 v42, v28, v38
    v_fmac_f32 v41, v30, v31
    v_fmac_f32 v42, v30, v39
    v_rcp_f32 v41, v41
    s_nop 0
    v_mul_f32 v11, v42, v41
    v_lshlrev_b32 v6, 2, v0
    ds_write_b32 v6, v8 offset:8192
    ds_write_b32 v6, v9 offset:10240
    ds_write_b32 v6, v10 offset:9216
    ds_write_b32 v6, v11 offset:11264
    s_waitcnt lgkmcnt(0)
    v_mov_b32 v61, 112
    v_mov_b32 v62, 1
    s_mov_b64 exec, 1
    ds_add_u32 v61, v62
    s_mov_b64 exec, -1
SB_36:
    ds_read_b32 v62, v61
    s_waitcnt lgkmcnt(0)
    v_readfirstlane_b32 s90, v62
    s_cmp_ge_u32 s90, 4
    s_cbranch_scc1 SB_36d
    s_sleep 1
    s_branch SB_36
SB_36d:
    v_lshlrev_b32 v7, 2, v2
    v_mov_b32 v40, 0
    v_mov_b32 v41, 0
    v_mov_b32 v42, 0
    v_mov_b32 v43, 0
    v_mov_b32 v44, 0
    v_mov_b32 v45, 0
    v_mov_b32 v46, 0
    v_mov_b32 v47, 0
    v_mov_b32 v48, 0
    v_mov_b32 v49, 0
    v_mov_b32 v50, 0
    v_mov_b32 v51, 0
    v_mov_b32 v52, 0
    v_mov_b32 v53, 0
    v_mov_b32 v54, 0
    v_mov_b32 v55, 0
    ds_read_b32 v8, v7 offset:8192
    ds_read_b32 v24, v7 offset:10240
    ds_read_b32 v9, v7 offset:8320
    ds_read_b32 v25, v7 offset:10368
    ds_read_b32 v10, v7 offset:8448
    ds_read_b32 v26, v7 offset:10496
    ds_read_b32 v11, v7 offset:8576
    ds_read_b32 v27, v7 offset:10624
    ds_read_b32 v12, v7 offset:8704
    ds_read_b32 v28, v7 offset:10752
    ds_read_b32 v13, v7 offset:8832
    ds_read_b32 v29, v7 offset:10880
    ds_read_b32 v14, v7 offset:8960
    ds_read_b32 v30, v7 offset:11008
    ds_read_b32 v15, v7 offset:9088
    ds_read_b32 v31, v7 offset:11136
    ds_read_b32 v16, v7 offset:9216
    ds_read_b32 v32, v7 offset:11264
    ds_read_b32 v17, v7 offset:9344
    ds_read_b32 v33, v7 offset:11392
    ds_read_b32 v18, v7 offset:9472
    ds_read_b32 v34, v7 offset:11520
    ds_read_b32 v19, v7 offset:9600
    ds_read_b32 v35, v7 offset:11648
    ds_read_b32 v20, v7 offset:9728
    ds_read_b32 v36, v7 offset:11776
    ds_read_b32 v21, v7 offset:9856
    ds_read_b32 v37, v7 offset:11904
    ds_read_b32 v22, v7 offset:9984
    ds_read_b32 v38, v7 offset:12032
    ds_read_b32 v23, v7 offset:10112
    ds_read_b32 v39, v7 offset:12160
    s_waitcnt vmcnt(0) lgkmcnt(0)
    v_accvgpr_read_b32 v60, a0
    v_lshlrev_b32 v4, 16, v60
    v_and_b32 v5, 0xffff0000, v60
    v_fmac_f32 v40, v4, v8
    v_fmac_f32 v41, v5, v8
    v_fmac_f32 v48, v4, v24
    v_fmac_f32 v49, v5, v24
    v_accvgpr_read_b32 v60, a1
    v_lshlrev_b32 v4, 16, v60
    v_and_b32 v5, 0xffff0000, v60
    v_fmac_f32 v42, v4, v8
    v_fmac_f32 v43, v5, v8
    v_fmac_f32 v50, v4, v24
    v_fmac_f32 v51, v5, v24
    v_accvgpr_read_b32 v60, a2
    v_lshlrev_b32 v4, 16, v60
    v_and_b32 v5, 0xffff0000, v60
    v_fmac_f32 v44, v4, v8
    v_fmac_f32 v45, v5, v8
    v_fmac_f32 v52, v4, v24
    v_fmac_f32 v53, v5, v24
    v_accvgpr_read_b32 v60, a3
    v_lshlrev_b32 v4, 16, v60
    v_and_b32 v5, 0xffff0000, v60
    v_fmac_f32 v46, v4, v8
    v_fmac_f32 v47, v5, v8
    v_fmac_f32 v54, v4, v24
    v_fmac_f32 v55, v5, v24
    v_accvgpr_read_b32 v60, a4
    v_lshlrev_b32 v4, 16, v60
    v_and_b32 v5, 0xffff0000, v60
    v_fmac_f32 v40, v4, v9
    v_fmac_f32 v41, v5, v9
    v_fmac_f32 v48, v4, v25
    v_fmac_f32 v49, v5, v25
    v_accvgpr_read_b32 v60, a5
    v_lshlrev_b32 v4, 16, v60
    v_and_b32 v5, 0xffff0000, v60
    v_fmac_f32 v42, v4, v9
    v_fmac_f32 v43, v5, v9
    v_fmac_f32 v50, v4, v25
    v_fmac_f32 v51, v5, v25
    v_accvgpr_read_b32 v60, a6
    v_lshlrev_b32 v4, 16, v60
    v_and_b32 v5, 0xffff0000, v60
    v_fmac_f32 v44, v4, v9
    v_fmac_f32 v45, v5, v9
    v_fmac_f32 v52, v4, v25
    v_fmac_f32 v53, v5, v25
    v_accvgpr_read_b32 v60, a7
    v_lshlrev_b32 v4, 16, v60
    v_and_b32 v5, 0xffff0000, v60
    v_fmac_f32 v46, v4, v9
    v_fmac_f32 v47, v5, v9
    v_fmac_f32 v54, v4, v25
    v_fmac_f32 v55, v5, v25
    v_accvgpr_read_b32 v60, a8
    v_lshlrev_b32 v4, 16, v60
    v_and_b32 v5, 0xffff0000, v60
    v_fmac_f32 v40, v4, v10
    v_fmac_f32 v41, v5, v10
    v_fmac_f32 v48, v4, v26
    v_fmac_f32 v49, v5, v26
    v_accvgpr_read_b32 v60, a9
    v_lshlrev_b32 v4, 16, v60
    v_and_b32 v5, 0xffff0000, v60
    v_fmac_f32 v42, v4, v10
    v_fmac_f32 v43, v5, v10
    v_fmac_f32 v50, v4, v26
    v_fmac_f32 v51, v5, v26
    v_accvgpr_read_b32 v60, a10
    v_lshlrev_b32 v4, 16, v60
    v_and_b32 v5, 0xffff0000, v60
    v_fmac_f32 v44, v4, v10
    v_fmac_f32 v45, v5, v10
    v_fmac_f32 v52, v4, v26
    v_fmac_f32 v53, v5, v26
    v_accvgpr_read_b32 v60, a11
    v_lshlrev_b32 v4, 16, v60
    v_and_b32 v5, 0xffff0000, v60
    v_fmac_f32 v46, v4, v10
    v_fmac_f32 v47, v5, v10
    v_fmac_f32 v54, v4, v26
    v_fmac_f32 v55, v5, v26
    v_accvgpr_read_b32 v60, a12
    v_lshlrev_b32 v4, 16, v60
    v_and_b32 v5, 0xffff0000, v60
    v_fmac_f32 v40, v4, v11
    v_fmac_f32 v41, v5, v11
    v_fmac_f32 v48, v4, v27
    v_fmac_f32 v49, v5, v27
    v_accvgpr_read_b32 v60, a13
    v_lshlrev_b32 v4, 16, v60
    v_and_b32 v5, 0xffff0000, v60
    v_fmac_f32 v42, v4, v11
    v_fmac_f32 v43, v5, v11
    v_fmac_f32 v50, v4, v27
    v_fmac_f32 v51, v5, v27
    v_accvgpr_read_b32 v60, a14
    v_lshlrev_b32 v4, 16, v60
    v_and_b32 v5, 0xffff0000, v60
    v_fmac_f32 v44, v4, v11
    v_fmac_f32 v45, v5, v11
    v_fmac_f32 v52, v4, v27
    v_fmac_f32 v53, v5, v27
    v_accvgpr_read_b32 v60, a15
    v_lshlrev_b32 v4, 16, v60
    v_and_b32 v5, 0xffff0000, v60
    v_fmac_f32 v46, v4, v11
    v_fmac_f32 v47, v5, v11
    v_fmac_f32 v54, v4, v27
    v_fmac_f32 v55, v5, v27
    v_accvgpr_read_b32 v60, a16
    v_lshlrev_b32 v4, 16, v60
    v_and_b32 v5, 0xffff0000, v60
    v_fmac_f32 v40, v4, v12
    v_fmac_f32 v41, v5, v12
    v_fmac_f32 v48, v4, v28
    v_fmac_f32 v49, v5, v28
    v_accvgpr_read_b32 v60, a17
    v_lshlrev_b32 v4, 16, v60
    v_and_b32 v5, 0xffff0000, v60
    v_fmac_f32 v42, v4, v12
    v_fmac_f32 v43, v5, v12
    v_fmac_f32 v50, v4, v28
    v_fmac_f32 v51, v5, v28
    v_accvgpr_read_b32 v60, a18
    v_lshlrev_b32 v4, 16, v60
    v_and_b32 v5, 0xffff0000, v60
    v_fmac_f32 v44, v4, v12
    v_fmac_f32 v45, v5, v12
    v_fmac_f32 v52, v4, v28
    v_fmac_f32 v53, v5, v28
    v_accvgpr_read_b32 v60, a19
    v_lshlrev_b32 v4, 16, v60
    v_and_b32 v5, 0xffff0000, v60
    v_fmac_f32 v46, v4, v12
    v_fmac_f32 v47, v5, v12
    v_fmac_f32 v54, v4, v28
    v_fmac_f32 v55, v5, v28
    v_accvgpr_read_b32 v60, a20
    v_lshlrev_b32 v4, 16, v60
    v_and_b32 v5, 0xffff0000, v60
    v_fmac_f32 v40, v4, v13
    v_fmac_f32 v41, v5, v13
    v_fmac_f32 v48, v4, v29
    v_fmac_f32 v49, v5, v29
    v_accvgpr_read_b32 v60, a21
    v_lshlrev_b32 v4, 16, v60
    v_and_b32 v5, 0xffff0000, v60
    v_fmac_f32 v42, v4, v13
    v_fmac_f32 v43, v5, v13
    v_fmac_f32 v50, v4, v29
    v_fmac_f32 v51, v5, v29
    v_accvgpr_read_b32 v60, a22
    v_lshlrev_b32 v4, 16, v60
    v_and_b32 v5, 0xffff0000, v60
    v_fmac_f32 v44, v4, v13
    v_fmac_f32 v45, v5, v13
    v_fmac_f32 v52, v4, v29
    v_fmac_f32 v53, v5, v29
    v_accvgpr_read_b32 v60, a23
    v_lshlrev_b32 v4, 16, v60
    v_and_b32 v5, 0xffff0000, v60
    v_fmac_f32 v46, v4, v13
    v_fmac_f32 v47, v5, v13
    v_fmac_f32 v54, v4, v29
    v_fmac_f32 v55, v5, v29
    v_accvgpr_read_b32 v60, a24
    v_lshlrev_b32 v4, 16, v60
    v_and_b32 v5, 0xffff0000, v60
    v_fmac_f32 v40, v4, v14
    v_fmac_f32 v41, v5, v14
    v_fmac_f32 v48, v4, v30
    v_fmac_f32 v49, v5, v30
    v_accvgpr_read_b32 v60, a25
    v_lshlrev_b32 v4, 16, v60
    v_and_b32 v5, 0xffff0000, v60
    v_fmac_f32 v42, v4, v14
    v_fmac_f32 v43, v5, v14
    v_fmac_f32 v50, v4, v30
    v_fmac_f32 v51, v5, v30
    v_accvgpr_read_b32 v60, a26
    v_lshlrev_b32 v4, 16, v60
    v_and_b32 v5, 0xffff0000, v60
    v_fmac_f32 v44, v4, v14
    v_fmac_f32 v45, v5, v14
    v_fmac_f32 v52, v4, v30
    v_fmac_f32 v53, v5, v30
    v_accvgpr_read_b32 v60, a27
    v_lshlrev_b32 v4, 16, v60
    v_and_b32 v5, 0xffff0000, v60
    v_fmac_f32 v46, v4, v14
    v_fmac_f32 v47, v5, v14
    v_fmac_f32 v54, v4, v30
    v_fmac_f32 v55, v5, v30
    v_accvgpr_read_b32 v60, a28
    v_lshlrev_b32 v4, 16, v60
    v_and_b32 v5, 0xffff0000, v60
    v_fmac_f32 v40, v4, v15
    v_fmac_f32 v41, v5, v15
    v_fmac_f32 v48, v4, v31
    v_fmac_f32 v49, v5, v31
    v_accvgpr_read_b32 v60, a29
    v_lshlrev_b32 v4, 16, v60
    v_and_b32 v5, 0xffff0000, v60
    v_fmac_f32 v42, v4, v15
    v_fmac_f32 v43, v5, v15
    v_fmac_f32 v50, v4, v31
    v_fmac_f32 v51, v5, v31
    v_accvgpr_read_b32 v60, a30
    v_lshlrev_b32 v4, 16, v60
    v_and_b32 v5, 0xffff0000, v60
    v_fmac_f32 v44, v4, v15
    v_fmac_f32 v45, v5, v15
    v_fmac_f32 v52, v4, v31
    v_fmac_f32 v53, v5, v31
    v_accvgpr_read_b32 v60, a31
    v_lshlrev_b32 v4, 16, v60
    v_and_b32 v5, 0xffff0000, v60
    v_fmac_f32 v46, v4, v15
    v_fmac_f32 v47, v5, v15
    v_fmac_f32 v54, v4, v31
    v_fmac_f32 v55, v5, v31
    v_accvgpr_read_b32 v60, a32
    v_lshlrev_b32 v4, 16, v60
    v_and_b32 v5, 0xffff0000, v60
    v_fmac_f32 v40, v4, v16
    v_fmac_f32 v41, v5, v16
    v_fmac_f32 v48, v4, v32
    v_fmac_f32 v49, v5, v32
    v_accvgpr_read_b32 v60, a33
    v_lshlrev_b32 v4, 16, v60
    v_and_b32 v5, 0xffff0000, v60
    v_fmac_f32 v42, v4, v16
    v_fmac_f32 v43, v5, v16
    v_fmac_f32 v50, v4, v32
    v_fmac_f32 v51, v5, v32
    v_accvgpr_read_b32 v60, a34
    v_lshlrev_b32 v4, 16, v60
    v_and_b32 v5, 0xffff0000, v60
    v_fmac_f32 v44, v4, v16
    v_fmac_f32 v45, v5, v16
    v_fmac_f32 v52, v4, v32
    v_fmac_f32 v53, v5, v32
    v_accvgpr_read_b32 v60, a35
    v_lshlrev_b32 v4, 16, v60
    v_and_b32 v5, 0xffff0000, v60
    v_fmac_f32 v46, v4, v16
    v_fmac_f32 v47, v5, v16
    v_fmac_f32 v54, v4, v32
    v_fmac_f32 v55, v5, v32
    v_accvgpr_read_b32 v60, a36
    v_lshlrev_b32 v4, 16, v60
    v_and_b32 v5, 0xffff0000, v60
    v_fmac_f32 v40, v4, v17
    v_fmac_f32 v41, v5, v17
    v_fmac_f32 v48, v4, v33
    v_fmac_f32 v49, v5, v33
    v_accvgpr_read_b32 v60, a37
    v_lshlrev_b32 v4, 16, v60
    v_and_b32 v5, 0xffff0000, v60
    v_fmac_f32 v42, v4, v17
    v_fmac_f32 v43, v5, v17
    v_fmac_f32 v50, v4, v33
    v_fmac_f32 v51, v5, v33
    v_accvgpr_read_b32 v60, a38
    v_lshlrev_b32 v4, 16, v60
    v_and_b32 v5, 0xffff0000, v60
    v_fmac_f32 v44, v4, v17
    v_fmac_f32 v45, v5, v17
    v_fmac_f32 v52, v4, v33
    v_fmac_f32 v53, v5, v33
    v_accvgpr_read_b32 v60, a39
    v_lshlrev_b32 v4, 16, v60
    v_and_b32 v5, 0xffff0000, v60
    v_fmac_f32 v46, v4, v17
    v_fmac_f32 v47, v5, v17
    v_fmac_f32 v54, v4, v33
    v_fmac_f32 v55, v5, v33
    v_accvgpr_read_b32 v60, a40
    v_lshlrev_b32 v4, 16, v60
    v_and_b32 v5, 0xffff0000, v60
    v_fmac_f32 v40, v4, v18
    v_fmac_f32 v41, v5, v18
    v_fmac_f32 v48, v4, v34
    v_fmac_f32 v49, v5, v34
    v_accvgpr_read_b32 v60, a41
    v_lshlrev_b32 v4, 16, v60
    v_and_b32 v5, 0xffff0000, v60
    v_fmac_f32 v42, v4, v18
    v_fmac_f32 v43, v5, v18
    v_fmac_f32 v50, v4, v34
    v_fmac_f32 v51, v5, v34
    v_accvgpr_read_b32 v60, a42
    v_lshlrev_b32 v4, 16, v60
    v_and_b32 v5, 0xffff0000, v60
    v_fmac_f32 v44, v4, v18
    v_fmac_f32 v45, v5, v18
    v_fmac_f32 v52, v4, v34
    v_fmac_f32 v53, v5, v34
    v_accvgpr_read_b32 v60, a43
    v_lshlrev_b32 v4, 16, v60
    v_and_b32 v5, 0xffff0000, v60
    v_fmac_f32 v46, v4, v18
    v_fmac_f32 v47, v5, v18
    v_fmac_f32 v54, v4, v34
    v_fmac_f32 v55, v5, v34
    v_accvgpr_read_b32 v60, a44
    v_lshlrev_b32 v4, 16, v60
    v_and_b32 v5, 0xffff0000, v60
    v_fmac_f32 v40, v4, v19
    v_fmac_f32 v41, v5, v19
    v_fmac_f32 v48, v4, v35
    v_fmac_f32 v49, v5, v35
    v_accvgpr_read_b32 v60, a45
    v_lshlrev_b32 v4, 16, v60
    v_and_b32 v5, 0xffff0000, v60
    v_fmac_f32 v42, v4, v19
    v_fmac_f32 v43, v5, v19
    v_fmac_f32 v50, v4, v35
    v_fmac_f32 v51, v5, v35
    v_accvgpr_read_b32 v60, a46
    v_lshlrev_b32 v4, 16, v60
    v_and_b32 v5, 0xffff0000, v60
    v_fmac_f32 v44, v4, v19
    v_fmac_f32 v45, v5, v19
    v_fmac_f32 v52, v4, v35
    v_fmac_f32 v53, v5, v35
    v_accvgpr_read_b32 v60, a47
    v_lshlrev_b32 v4, 16, v60
    v_and_b32 v5, 0xffff0000, v60
    v_fmac_f32 v46, v4, v19
    v_fmac_f32 v47, v5, v19
    v_fmac_f32 v54, v4, v35
    v_fmac_f32 v55, v5, v35
    v_accvgpr_read_b32 v60, a48
    v_lshlrev_b32 v4, 16, v60
    v_and_b32 v5, 0xffff0000, v60
    v_fmac_f32 v40, v4, v20
    v_fmac_f32 v41, v5, v20
    v_fmac_f32 v48, v4, v36
    v_fmac_f32 v49, v5, v36
    v_accvgpr_read_b32 v60, a49
    v_lshlrev_b32 v4, 16, v60
    v_and_b32 v5, 0xffff0000, v60
    v_fmac_f32 v42, v4, v20
    v_fmac_f32 v43, v5, v20
    v_fmac_f32 v50, v4, v36
    v_fmac_f32 v51, v5, v36
    v_accvgpr_read_b32 v60, a50
    v_lshlrev_b32 v4, 16, v60
    v_and_b32 v5, 0xffff0000, v60
    v_fmac_f32 v44, v4, v20
    v_fmac_f32 v45, v5, v20
    v_fmac_f32 v52, v4, v36
    v_fmac_f32 v53, v5, v36
    v_accvgpr_read_b32 v60, a51
    v_lshlrev_b32 v4, 16, v60
    v_and_b32 v5, 0xffff0000, v60
    v_fmac_f32 v46, v4, v20
    v_fmac_f32 v47, v5, v20
    v_fmac_f32 v54, v4, v36
    v_fmac_f32 v55, v5, v36
    v_accvgpr_read_b32 v60, a52
    v_lshlrev_b32 v4, 16, v60
    v_and_b32 v5, 0xffff0000, v60
    v_fmac_f32 v40, v4, v21
    v_fmac_f32 v41, v5, v21
    v_fmac_f32 v48, v4, v37
    v_fmac_f32 v49, v5, v37
    v_accvgpr_read_b32 v60, a53
    v_lshlrev_b32 v4, 16, v60
    v_and_b32 v5, 0xffff0000, v60
    v_fmac_f32 v42, v4, v21
    v_fmac_f32 v43, v5, v21
    v_fmac_f32 v50, v4, v37
    v_fmac_f32 v51, v5, v37
    v_accvgpr_read_b32 v60, a54
    v_lshlrev_b32 v4, 16, v60
    v_and_b32 v5, 0xffff0000, v60
    v_fmac_f32 v44, v4, v21
    v_fmac_f32 v45, v5, v21
    v_fmac_f32 v52, v4, v37
    v_fmac_f32 v53, v5, v37
    v_accvgpr_read_b32 v60, a55
    v_lshlrev_b32 v4, 16, v60
    v_and_b32 v5, 0xffff0000, v60
    v_fmac_f32 v46, v4, v21
    v_fmac_f32 v47, v5, v21
    v_fmac_f32 v54, v4, v37
    v_fmac_f32 v55, v5, v37
    v_accvgpr_read_b32 v60, a56
    v_lshlrev_b32 v4, 16, v60
    v_and_b32 v5, 0xffff0000, v60
    v_fmac_f32 v40, v4, v22
    v_fmac_f32 v41, v5, v22
    v_fmac_f32 v48, v4, v38
    v_fmac_f32 v49, v5, v38
    v_accvgpr_read_b32 v60, a57
    v_lshlrev_b32 v4, 16, v60
    v_and_b32 v5, 0xffff0000, v60
    v_fmac_f32 v42, v4, v22
    v_fmac_f32 v43, v5, v22
    v_fmac_f32 v50, v4, v38
    v_fmac_f32 v51, v5, v38
    v_accvgpr_read_b32 v60, a58
    v_lshlrev_b32 v4, 16, v60
    v_and_b32 v5, 0xffff0000, v60
    v_fmac_f32 v44, v4, v22
    v_fmac_f32 v45, v5, v22
    v_fmac_f32 v52, v4, v38
    v_fmac_f32 v53, v5, v38
    v_accvgpr_read_b32 v60, a59
    v_lshlrev_b32 v4, 16, v60
    v_and_b32 v5, 0xffff0000, v60
    v_fmac_f32 v46, v4, v22
    v_fmac_f32 v47, v5, v22
    v_fmac_f32 v54, v4, v38
    v_fmac_f32 v55, v5, v38
    v_accvgpr_read_b32 v60, a60
    v_lshlrev_b32 v4, 16, v60
    v_and_b32 v5, 0xffff0000, v60
    v_fmac_f32 v40, v4, v23
    v_fmac_f32 v41, v5, v23
    v_fmac_f32 v48, v4, v39
    v_fmac_f32 v49, v5, v39
    v_accvgpr_read_b32 v60, a61
    v_lshlrev_b32 v4, 16, v60
    v_and_b32 v5, 0xffff0000, v60
    v_fmac_f32 v42, v4, v23
    v_fmac_f32 v43, v5, v23
    v_fmac_f32 v50, v4, v39
    v_fmac_f32 v51, v5, v39
    v_accvgpr_read_b32 v60, a62
    v_lshlrev_b32 v4, 16, v60
    v_and_b32 v5, 0xffff0000, v60
    v_fmac_f32 v44, v4, v23
    v_fmac_f32 v45, v5, v23
    v_fmac_f32 v52, v4, v39
    v_fmac_f32 v53, v5, v39
    v_accvgpr_read_b32 v60, a63
    v_lshlrev_b32 v4, 16, v60
    v_and_b32 v5, 0xffff0000, v60
    v_fmac_f32 v46, v4, v23
    v_fmac_f32 v47, v5, v23
    v_fmac_f32 v54, v4, v39
    v_fmac_f32 v55, v5, v39
    v_lshlrev_b32 v7, 9, v2
    v_lshl_add_u32 v7, v1, 5, v7
    ds_write_b128 v7, v[40:43] offset:16384
    ds_write_b128 v7, v[44:47] offset:16400
    ds_write_b128 v7, v[48:51] offset:16640
    ds_write_b128 v7, v[52:55] offset:16656
    s_waitcnt lgkmcnt(0)
    v_mov_b32 v61, 116
    v_mov_b32 v62, 1
    s_mov_b64 exec, 1
    ds_add_u32 v61, v62
    s_mov_b64 exec, -1
SB_37:
    ds_read_b32 v62, v61
    s_waitcnt lgkmcnt(0)
    v_readfirstlane_b32 s90, v62
    s_cmp_ge_u32 s90, 4
    s_cbranch_scc1 SB_37d
    s_sleep 1
    s_branch SB_37
SB_37d:
    s_cmp_ge_u32 s3, 2
    s_cbranch_scc1 L_opA_sk1
    v_lshlrev_b32 v7, 2, v0
    ds_read_b32 v8, v7 offset:16384
    ds_read_b32 v9, v7 offset:16896
    ds_read_b32 v10, v7 offset:17408
    ds_read_b32 v11, v7 offset:17920
    ds_read_b32 v12, v7 offset:18432
    ds_read_b32 v13, v7 offset:18944
    ds_read_b32 v14, v7 offset:19456
    ds_read_b32 v15, v7 offset:19968
    ds_read_b32 v16, v7 offset:20480
    ds_read_b32 v17, v7 offset:20992
    ds_read_b32 v18, v7 offset:21504
    ds_read_b32 v19, v7 offset:22016
    ds_read_b32 v20, v7 offset:22528
    ds_read_b32 v21, v7 offset:23040
    ds_read_b32 v22, v7 offset:23552
    ds_read_b32 v23, v7 offset:24064
    ds_read_b32 v24, v7 offset:24576
    ds_read_b32 v25, v7 offset:25088
    ds_read_b32 v26, v7 offset:25600
    ds_read_b32 v27, v7 offset:26112
    ds_read_b32 v28, v7 offset:26624
    ds_read_b32 v29, v7 offset:27136
    ds_read_b32 v30, v7 offset:27648
    ds_read_b32 v31, v7 offset:28160
    ds_read_b32 v32, v7 offset:28672
    ds_read_b32 v33, v7 offset:29184
    ds_read_b32 v34, v7 offset:29696
    ds_read_b32 v35, v7 offset:30208
    ds_read_b32 v36, v7 offset:30720
    ds_read_b32 v37, v7 offset:31232
    ds_read_b32 v38, v7 offset:31744
    ds_read_b32 v39, v7 offset:32256
    s_waitcnt lgkmcnt(0)
    v_add_f32 v8, v8, v24
    v_add_f32 v9, v9, v25
    v_add_f32 v10, v10, v26
    v_add_f32 v11, v11, v27
    v_add_f32 v12, v12, v28
    v_add_f32 v13, v13, v29
    v_add_f32 v14, v14, v30
    v_add_f32 v15, v15, v31
    v_add_f32 v16, v16, v32
    v_add_f32 v17, v17, v33
    v_add_f32 v18, v18, v34
    v_add_f32 v19, v19, v35
    v_add_f32 v20, v20, v36
    v_add_f32 v21, v21, v37
    v_add_f32 v22, v22, v38
    v_add_f32 v23, v23, v39
    v_add_f32 v8, v8, v16
    v_add_f32 v9, v9, v17
    v_add_f32 v10, v10, v18
    v_add_f32 v11, v11, v19
    v_add_f32 v12, v12, v20
    v_add_f32 v13, v13, v21
    v_add_f32 v14, v14, v22
    v_add_f32 v15, v15, v23
    v_add_f32 v8, v8, v12
    v_add_f32 v9, v9, v13
    v_add_f32 v10, v10, v14
    v_add_f32 v11, v11, v15
    v_add_f32 v8, v8, v10
    v_add_f32 v9, v9, v11
    v_add_f32 v8, v8, v9
    s_add_u32 s54, s64, 0
    s_lshl_b32 s54, s54, 3
    s_add_u32 s55, s54, s65
    s_lshl_b32 s55, s55, 9
    s_add_u32 s55, s55, 10485760
    buffer_store_dword v8, v7, s[32:35], s55 offen sc1
    s_waitcnt vmcnt(0)
L_opA_sk1:
    s_waitcnt lgkmcnt(0)
    v_mov_b32 v61, 120
    v_mov_b32 v62, 1
    s_mov_b64 exec, 1
    ds_add_u32 v61, v62
    s_mov_b64 exec, -1
SB_38:
    ds_read_b32 v62, v61
    s_waitcnt lgkmcnt(0)
    v_readfirstlane_b32 s90, v62
    s_cmp_ge_u32 s90, 4
    s_cbranch_scc1 SB_38d
    s_sleep 1
    s_branch SB_38
SB_38d:
    s_cmp_lg_u32 s3, 0
    s_cbranch_scc1 L_end
    s_add_u32 s54, s64, 32
    s_lshl_b32 s54, s54, 2
    v_mov_b32 v8, 1
    v_mov_b32 v9, s54
    s_mov_b64 exec, 1
    buffer_atomic_add v8, v9, s[36:39], 0 offen sc0
    s_waitcnt vmcnt(0)
    s_mov_b64 exec, -1
    v_readfirstlane_b32 s55, v8
    s_cmp_lg_u32 s55, 7
    s_cbranch_scc1 L_end
    v_lshlrev_b32 v7, 2, v56
    s_add_u32 s54, s64, 0
    s_lshl_b32 s54, s54, 12
    s_add_u32 s54, s54, 10485760
    buffer_load_dword v8, v7, s[32:35], s54 offen offset:0 sc1
    buffer_load_dword v16, v7, s[32:35], s54 offen offset:256 sc1
    buffer_load_dword v9, v7, s[32:35], s54 offen offset:512 sc1
    buffer_load_dword v17, v7, s[32:35], s54 offen offset:768 sc1
    buffer_load_dword v10, v7, s[32:35], s54 offen offset:1024 sc1
    buffer_load_dword v18, v7, s[32:35], s54 offen offset:1280 sc1
    buffer_load_dword v11, v7, s[32:35], s54 offen offset:1536 sc1
    buffer_load_dword v19, v7, s[32:35], s54 offen offset:1792 sc1
    buffer_load_dword v12, v7, s[32:35], s54 offen offset:2048 sc1
    buffer_load_dword v20, v7, s[32:35], s54 offen offset:2304 sc1
    buffer_load_dword v13, v7, s[32:35], s54 offen offset:2560 sc1
    buffer_load_dword v21, v7, s[32:35], s54 offen offset:2816 sc1
    buffer_load_dword v14, v7, s[32:35], s54 offen offset:3072 sc1
    buffer_load_dword v22, v7, s[32:35], s54 offen offset:3328 sc1
    buffer_load_dword v15, v7, s[32:35], s54 offen offset:3584 sc1
    buffer_load_dword v23, v7, s[32:35], s54 offen offset:3840 sc1
    s_waitcnt vmcnt(0)
    v_add_f32 v8, v8, v12
    v_add_f32 v16, v16, v20
    v_add_f32 v9, v9, v13
    v_add_f32 v17, v17, v21
    v_add_f32 v10, v10, v14
    v_add_f32 v18, v18, v22
    v_add_f32 v11, v11, v15
    v_add_f32 v19, v19, v23
    v_add_f32 v8, v8, v10
    v_add_f32 v16, v16, v18
    v_add_f32 v9, v9, v11
    v_add_f32 v17, v17, v19
    v_add_f32 v8, v8, v9
    v_add_f32 v16, v16, v17
    v_cvt_pk_bf16_f32 v8, v8, v8
    v_cvt_pk_bf16_f32 v16, v16, v16
    s_lshl_b32 s54, s64, 6
    s_add_u32 s54, s54, 0
    v_add_u32 v4, s54, v56
    v_lshlrev_b32 v4, 1, v4
    buffer_store_short v8, v4, s[48:51], 0 offen
    buffer_store_short v16, v4, s[48:51], 0 offen offset:2304
    s_branch L_end
L_end:
L_end2:
    s_endpgm
.section .rodata,"a"
.p2align 6
.amdhsa_kernel concat_heads__gqa_block_cached__compressed_kv_cla__decode_kernel
  .amdhsa_next_free_vgpr 256
  .amdhsa_next_free_sgpr 102
  .amdhsa_accum_offset 128
  .amdhsa_group_segment_fixed_size 0
  .amdhsa_kernarg_size 112
  .amdhsa_user_sgpr_count 2
  .amdhsa_user_sgpr_kernarg_segment_ptr 1
  .amdhsa_system_sgpr_workgroup_id_x 1
  .amdhsa_float_denorm_mode_32 3
.end_amdhsa_kernel
```
